```python
import torch

def _softmax(x, axis=-1):
    return torch.softmax(x, dim=axis)
def _gelu(x):
    return torch.nn.functional.gelu(x, approximate="tanh")
def _silu(x):
    return torch.nn.functional.silu(x)
def _sigmoid(x):
    return torch.sigmoid(x)
def _layernorm(x, axis=-1, eps=1e-5):
    m = x.mean(dim=axis, keepdim=True)
    v = x.var(dim=axis, keepdim=True, unbiased=False)
    return (x - m) / torch.sqrt(v + eps)
def _scatter_add(tgt, idx, src, axis=0):
    return tgt.clone().index_add_(axis, idx, src)
def _segment_sum(src, seg, n):
    out = torch.zeros((n,) + src.shape[1:], dtype=src.dtype)
    return out.index_add_(0, seg, src)
def _pad(x, pw):
    flat = tuple(v for pair in reversed(pw) for v in pair)
    return torch.nn.functional.pad(x, flat)

kernel_name = 'gated_mix__softmax_full_mha__dense_activation_gelu__prompt'

def setup_inputs():

    _w = (lambda a: (lambda t: t.to(torch.bfloat16) if t.is_floating_point() else t)(torch.as_tensor(a)))
    def _A_setup():
        B, S, D = 1, 2048, 512
        return {
            "x": _w((lambda *s: torch.randn(*s, dtype=torch.bfloat16) * 0.05)(B, S, D)),
            "wqkv": _w((lambda *s: torch.randn(*s, dtype=torch.bfloat16) * 0.8)(D, 3 * D)),
            "wo": _w((lambda *s: torch.randn(*s, dtype=torch.bfloat16) * 0.05)(D, D)),
        }
    _A_in = _A_setup()

    def _B_setup():
        B, S, D, F = 1, 2048, 512, 1792
        return {
            "x": _w((lambda *s: torch.randn(*s, dtype=torch.bfloat16) * 0.05)(B, S, D)),
            "w1": _w((lambda *s: torch.randn(*s, dtype=torch.bfloat16) * 3.2)(D, F) * (D ** -0.5)),
            "b1": _w((lambda *s: torch.randn(*s, dtype=torch.bfloat16) * 3.2)(F) * 0.01),
            "w2": _w((lambda *s: torch.randn(*s, dtype=torch.bfloat16) * 0.8)(F, D) * (F ** -0.5)),
            "b2": _w((lambda *s: torch.randn(*s, dtype=torch.bfloat16) * 1.6)(D) * 0.01),
        }
    _B_in = _B_setup()

    return {
        "A_x": _A_in["x"],
        "A_wqkv": _A_in["wqkv"],
        "A_wo": _A_in["wo"],
        "B_x": _B_in["x"],
        "B_w1": _B_in["w1"],
        "B_b1": _B_in["b1"],
        "B_w2": _B_in["w2"],
        "B_b2": _B_in["b2"],
        "gate_w": _w((lambda *s: torch.randn(*s, dtype=torch.bfloat16) * 0.05)(512) * 16.0),
    }

def reference(A_x, A_wqkv, A_wo, B_x, B_w1, B_b1, B_w2, B_b2, gate_w):
    def _A_ref(x, wqkv, wo):
        B, S, D = x.shape
        H = 32; Dh = D // H
        qkv = (lambda x, *d: x.permute(*d))((x @ wqkv).reshape(B, S, 3, H, Dh), 2, 0, 3, 1, 4)
        q, k, v = qkv[0], qkv[1], qkv[2]
        scale = Dh ** -0.5
        scores = torch.einsum("bhqd,bhkd->bhqk", q, k) * scale
        p = _softmax(scores, axis=-1)
        o = torch.einsum("bhqk,bhkd->bhqd", p, v)
        return (lambda x, *d: x.permute(*d))(o, 0, 2, 1, 3).reshape(B, S, D) @ wo

    def _B_ref(x, w1, b1, w2, b2):
        h = torch.einsum("bsd,df->bsf", x, w1) + b1
        h = _gelu(h)
        return torch.einsum("bsf,fd->bsd", h, w2) + b2

    x = A_x
    g = _sigmoid((x * gate_w).sum(-1, keepdims=True))
    a = _A_ref(x, A_wqkv, A_wo)
    b = _B_ref(x, B_w1, B_b1, B_w2, B_b2)
    return g * a + (1 - g) * b
```

```asm
; @launch grid=(256,1,1) block=(512,1,1) lds=163840
.amdgcn_target "amdgcn-amd-amdhsa--gfx950"
.text
.globl gated_mix__softmax_full_mha__dense_activation_gelu__prompt_kernel
.p2align 8
.type gated_mix__softmax_full_mha__dense_activation_gelu__prompt_kernel,@function
gated_mix__softmax_full_mha__dense_activation_gelu__prompt_kernel:
    s_cmp_ge_u32 s2, 256
    s_cbranch_scc1 L_end
    s_load_dwordx16 s[4:19], s[0:1], 0
    s_load_dwordx8 s[20:27], s[0:1], 64
    v_lshrrev_b32 v12, 6, v0
    v_and_b32 v1, 63, v0
    v_readfirstlane_b32 s3, v12
    v_lshlrev_b32 v2, 4, v1
    v_mov_b32 v3, 0
    v_mov_b32 v4, 1
    s_and_b32 s56, s2, 7
    s_lshr_b32 s57, s2, 3
    s_and_b32 s58, s57, 3
    s_and_b32 s53, s56, 3
    s_lshl_b32 s53, s53, 2
    s_add_u32 s53, s53, s58
    s_lshl_b32 s68, s56, 2
    s_add_u32 s68, s68, s58
    s_lshr_b32 s69, s57, 2
    s_lshr_b32 s54, s56, 2
    s_lshl_b32 s54, s54, 3
    s_add_u32 s54, s54, s69
    s_lshl_b32 s58, s58, 1
    s_add_u32 s58, s58, s69
    s_and_b32 s52, s3, 3
    s_lshl_b32 s55, s54, 2
    s_add_u32 s55, s55, s52
    s_add_u32 s60, s58, 0
    s_and_b32 s60, s60, 7
    s_add_u32 s61, s58, 1
    s_and_b32 s61, s61, 7
    s_add_u32 s62, s58, 2
    s_and_b32 s62, s62, 7
    s_add_u32 s63, s58, 3
    s_and_b32 s63, s63, 7
    s_add_u32 s64, s58, 4
    s_and_b32 s64, s64, 7
    s_add_u32 s65, s58, 5
    s_and_b32 s65, s65, 7
    s_add_u32 s66, s58, 6
    s_and_b32 s66, s66, 7
    s_add_u32 s67, s58, 7
    s_and_b32 s67, s67, 7
    s_cmp_lt_u32 s3, 4
    s_mov_b32 s3, 200000
    s_cbranch_scc1 L_A
    s_setprio 2
    v_lshrrev_b32 v12, 3, v1
    v_lshlrev_b32 v20, 10, v12
    v_and_b32 v12, 7, v1
    v_lshrrev_b32 v13, 4, v1
    v_xor_b32 v12, v12, v13
    v_lshl_add_u32 v20, v12, 4, v20
    v_xor_b32 v21, 64, v20
    v_lshrrev_b32 v12, 2, v1
    v_and_b32 v13, 3, v1
    v_lshlrev_b32 v13, 4, v13
    v_mul_u32_u24 v22, 3072, v12
    v_add_u32 v22, v22, v13
    v_mul_u32_u24 v23, 3584, v12
    v_add_u32 v23, v23, v13
    s_lshl_b32 s72, s55, 15
    s_mul_i32 s73, s52, 49152
    s_mul_i32 s56, s53, 192
    s_add_u32 s73, s73, s56
    s_lshl_b32 s75, s52, 12
    s_lshl_b32 s76, s52, 10
    s_waitcnt lgkmcnt(0)
    s_mov_b32 s28, s4
    s_mov_b32 s29, s5
    s_mov_b32 s30, 0x200000
    s_mov_b32 s31, 0x00020000
    s_mov_b32 s32, s6
    s_mov_b32 s33, s7
    s_mov_b32 s34, 0x180000
    s_mov_b32 s35, 0x00020000
    s_lshl_b32 s81, s60, 7
    s_add_u32 s81, s81, s72
    s_add_u32 m0, s75, 12288
    s_add_u32 s57, s81, 0
    buffer_load_dwordx4 v20, s[28:31], s57 offen lds
    s_add_u32 m0, s75, 13312
    s_add_u32 s57, s81, 8192
    buffer_load_dwordx4 v21, s[28:31], s57 offen lds
    s_add_u32 m0, s75, 14336
    s_add_u32 s57, s81, 16384
    buffer_load_dwordx4 v20, s[28:31], s57 offen lds
    s_add_u32 m0, s75, 15360
    s_add_u32 s57, s81, 24576
    buffer_load_dwordx4 v21, s[28:31], s57 offen lds
    s_mul_i32 s81, s60, 196608
    s_add_u32 s81, s81, s73
    s_add_u32 m0, s76, 77824
    s_add_u32 s57, s81, 0
    buffer_load_dwordx4 v22, s[32:35], s57 offen lds
    s_add_u32 m0, s76, 81920
    s_add_u32 s57, s81, 64
    buffer_load_dwordx4 v22, s[32:35], s57 offen lds
    s_add_u32 m0, s76, 86016
    s_add_u32 s57, s81, 128
    buffer_load_dwordx4 v22, s[32:35], s57 offen lds
    s_lshl_b32 s81, s61, 7
    s_add_u32 s81, s81, s72
    s_add_u32 m0, s75, 28672
    s_add_u32 s57, s81, 0
    buffer_load_dwordx4 v20, s[28:31], s57 offen lds
    s_add_u32 m0, s75, 29696
    s_add_u32 s57, s81, 8192
    buffer_load_dwordx4 v21, s[28:31], s57 offen lds
    s_add_u32 m0, s75, 30720
    s_add_u32 s57, s81, 16384
    buffer_load_dwordx4 v20, s[28:31], s57 offen lds
    s_add_u32 m0, s75, 31744
    s_add_u32 s57, s81, 24576
    buffer_load_dwordx4 v21, s[28:31], s57 offen lds
    s_mov_b32 s36, s12
    s_mov_b32 s37, s13
    s_mov_b32 s38, 0x1c0000
    s_mov_b32 s39, 0x00020000
    s_mov_b32 s40, s26
    s_mov_b32 s41, s27
    s_mov_b32 s42, 0x2800000
    s_mov_b32 s43, 0x00020000
    s_mul_i32 s74, s52, 57344
    s_mul_i32 s58, s53, 224
    s_add_u32 s74, s74, s58
    s_mov_b32 s78, 0x33333333
    s_mov_b32 s79, 0x33333333
    v_lshrrev_b32 v12, 5, v1
    v_and_b32 v13, 31, v1
    v_bfe_u32 v14, v1, 1, 3
    v_xor_b32 v14, v14, v12
    v_lshlrev_b32 v14, 4, v14
    v_lshl_add_u32 v5, v13, 7, v14
    s_lshl_b32 s56, s52, 12
    s_add_u32 s56, s56, 12288
    v_add_u32 v5, s56, v5
    v_xor_b32 v6, 32, v5
    v_xor_b32 v7, 64, v5
    v_xor_b32 v8, 96, v5
    v_bfe_u32 v14, v1, 2, 2
    v_lshlrev_b32 v14, 6, v14
    v_bfe_u32 v15, v1, 4, 1
    v_lshl_add_u32 v14, v15, 5, v14
    v_and_b32 v15, 3, v1
    v_lshl_add_u32 v14, v15, 3, v14
    v_lshl_add_u32 v9, v12, 9, v14
    v_add_u32 v10, 0x10000, v9
    v_add_u32 v11, 0x20000, v9
    v_lshlrev_b32 v16, 3, v12
    v_and_b32 v14, 15, v1
    v_bfe_u32 v15, v1, 4, 1
    v_lshlrev_b32 v24, 6, v14
    v_lshl_add_u32 v24, v15, 3, v24
    s_add_u32 s56, s76, 24608
    v_add_u32 v24, s56, v24
    v_lshlrev_b32 v17, 1, v14
    s_lshl_b32 s56, s52, 5
    v_add_u32 v17, s56, v17
    s_mul_i32 s81, s61, 196608
    s_add_u32 s81, s81, s73
    s_add_u32 m0, s76, 90112
    s_add_u32 s57, s81, 0
    buffer_load_dwordx4 v22, s[32:35], s57 offen lds
    s_add_u32 m0, s76, 94208
    s_add_u32 s57, s81, 64
    buffer_load_dwordx4 v22, s[32:35], s57 offen lds
    s_add_u32 m0, s76, 98304
    s_add_u32 s57, s81, 128
    buffer_load_dwordx4 v22, s[32:35], s57 offen lds
    s_lshl_b32 s81, s62, 7
    s_add_u32 s81, s81, s72
    s_add_u32 m0, s75, 45056
    s_add_u32 s57, s81, 0
    buffer_load_dwordx4 v20, s[28:31], s57 offen lds
    s_add_u32 m0, s75, 46080
    s_add_u32 s57, s81, 8192
    buffer_load_dwordx4 v21, s[28:31], s57 offen lds
    s_add_u32 m0, s75, 47104
    s_add_u32 s57, s81, 16384
    buffer_load_dwordx4 v20, s[28:31], s57 offen lds
    s_add_u32 m0, s75, 48128
    s_add_u32 s57, s81, 24576
    buffer_load_dwordx4 v21, s[28:31], s57 offen lds
    s_waitcnt vmcnt(11)
    s_barrier
    ds_read_b128 a[0:3], v5 offset:0
    ds_read_b128 a[4:7], v6 offset:0
    ds_read_b128 a[8:11], v7 offset:0
    ds_read_b128 a[12:15], v8 offset:0
    s_mul_i32 s81, s62, 196608
    s_add_u32 s81, s81, s73
    s_add_u32 m0, s76, 102400
    s_add_u32 s57, s81, 0
    buffer_load_dwordx4 v22, s[32:35], s57 offen lds
    s_add_u32 m0, s76, 106496
    s_add_u32 s57, s81, 64
    buffer_load_dwordx4 v22, s[32:35], s57 offen lds
    s_add_u32 m0, s76, 110592
    s_add_u32 s57, s81, 128
    buffer_load_dwordx4 v22, s[32:35], s57 offen lds
    s_lshl_b32 s81, s63, 7
    s_add_u32 s81, s81, s72
    s_add_u32 m0, s75, 61440
    s_add_u32 s57, s81, 0
    buffer_load_dwordx4 v20, s[28:31], s57 offen lds
    s_add_u32 m0, s75, 62464
    s_add_u32 s57, s81, 8192
    buffer_load_dwordx4 v21, s[28:31], s57 offen lds
    s_add_u32 m0, s75, 63488
    s_add_u32 s57, s81, 16384
    buffer_load_dwordx4 v20, s[28:31], s57 offen lds
    s_add_u32 m0, s75, 64512
    s_add_u32 s57, s81, 24576
    buffer_load_dwordx4 v21, s[28:31], s57 offen lds
    s_waitcnt vmcnt(11)
    s_waitcnt lgkmcnt(0)
    s_barrier
    ds_read_b128 a[16:19], v5 offset:16384
    ds_read_b128 a[20:23], v6 offset:16384
    ds_read_b128 a[24:27], v7 offset:16384
    ds_read_b128 a[28:31], v8 offset:16384
    s_mul_i32 s81, s60, 229376
    s_add_u32 s81, s81, s74
    s_add_u32 m0, s76, 114688
    s_add_u32 s57, s81, 0
    buffer_load_dwordx4 v23, s[36:39], s57 offen lds
    ds_read_b64 v[32:33], v16 offset:1280
    ds_read_b64 v[34:35], v16 offset:1296
    ds_read_b64 v[36:37], v16 offset:1312
    ds_read_b64 v[38:39], v16 offset:1328
    ds_read_b64 v[40:41], v16 offset:1344
    ds_read_b64 v[42:43], v16 offset:1360
    s_add_u32 m0, s76, 118784
    s_add_u32 s57, s81, 64
    buffer_load_dwordx4 v23, s[36:39], s57 offen lds
    ds_read_b64 v[44:45], v16 offset:1376
    ds_read_b64 v[46:47], v16 offset:1392
    ds_read_b64 v[48:49], v16 offset:1408
    ds_read_b64 v[50:51], v16 offset:1424
    ds_read_b64 v[52:53], v16 offset:1440
    ds_read_b64 v[54:55], v16 offset:1456
    s_add_u32 m0, s76, 122880
    s_add_u32 s57, s81, 128
    buffer_load_dwordx4 v23, s[36:39], s57 offen lds
    ds_read_b64 v[56:57], v16 offset:1472
    ds_read_b64 v[58:59], v16 offset:1488
    s_lshl_b32 s56, s60, 7
    v_add_u32 v18, s56, v17
    ds_read_u16 v25, v18 offset:256
    s_lshl_b32 s56, s61, 7
    s_add_u32 m0, s76, 126976
    s_add_u32 s57, s81, 192
    s_mov_b64 exec, s[78:79]
    buffer_load_dwordx4 v23, s[36:39], s57 offen lds
    s_mov_b64 exec, -1
    v_add_u32 v18, s56, v17
    ds_read_u16 v26, v18 offset:256
    s_lshl_b32 s56, s62, 7
    v_add_u32 v18, s56, v17
    ds_read_u16 v27, v18 offset:256
    s_lshl_b32 s56, s63, 7
    s_mul_i32 s81, s63, 196608
    s_add_u32 s81, s81, s73
    s_add_u32 m0, s76, 77824
    s_add_u32 s57, s81, 0
    buffer_load_dwordx4 v22, s[32:35], s57 offen lds
    v_add_u32 v18, s56, v17
    ds_read_u16 v28, v18 offset:256
    s_lshl_b32 s56, s64, 7
    v_add_u32 v18, s56, v17
    ds_read_u16 v29, v18 offset:256
    s_lshl_b32 s56, s65, 7
    s_add_u32 m0, s76, 81920
    s_add_u32 s57, s81, 64
    buffer_load_dwordx4 v22, s[32:35], s57 offen lds
    v_add_u32 v18, s56, v17
    ds_read_u16 v30, v18 offset:256
    s_lshl_b32 s56, s66, 7
    v_add_u32 v18, s56, v17
    ds_read_u16 v31, v18 offset:256
    s_lshl_b32 s56, s67, 7
    s_add_u32 m0, s76, 86016
    s_add_u32 s57, s81, 128
    buffer_load_dwordx4 v22, s[32:35], s57 offen lds
    v_add_u32 v18, s56, v17
    ds_read_u16 v0, v18 offset:256
    s_lshl_b32 s81, s64, 7
    s_add_u32 s81, s81, s72
    s_add_u32 m0, s75, 12288
    s_add_u32 s57, s81, 0
    buffer_load_dwordx4 v20, s[28:31], s57 offen lds
    s_add_u32 m0, s75, 13312
    s_add_u32 s57, s81, 8192
    buffer_load_dwordx4 v21, s[28:31], s57 offen lds
    s_add_u32 m0, s75, 14336
    s_add_u32 s57, s81, 16384
    buffer_load_dwordx4 v20, s[28:31], s57 offen lds
    s_add_u32 m0, s75, 15360
    s_add_u32 s57, s81, 24576
    buffer_load_dwordx4 v21, s[28:31], s57 offen lds
    s_waitcnt vmcnt(15)
    s_waitcnt lgkmcnt(0)
    s_barrier
    ds_read_b128 a[32:35], v5 offset:32768
    ds_read_b128 a[36:39], v6 offset:32768
    ds_read_b128 a[40:43], v7 offset:32768
    ds_read_b128 a[44:47], v8 offset:32768
    s_mul_i32 s81, s64, 196608
    s_add_u32 s81, s81, s73
    s_add_u32 m0, s76, 90112
    s_add_u32 s57, s81, 0
    buffer_load_dwordx4 v22, s[32:35], s57 offen lds
    v_lshlrev_b32 v64, 16, v32
    v_and_b32 v65, 0xffff0000, v32
    v_lshlrev_b32 v66, 16, v33
    v_and_b32 v67, 0xffff0000, v33
    v_lshlrev_b32 v68, 16, v34
    v_and_b32 v69, 0xffff0000, v34
    s_add_u32 m0, s76, 94208
    s_add_u32 s57, s81, 64
    buffer_load_dwordx4 v22, s[32:35], s57 offen lds
    v_lshlrev_b32 v70, 16, v35
    v_and_b32 v71, 0xffff0000, v35
    v_lshlrev_b32 v72, 16, v36
    v_and_b32 v73, 0xffff0000, v36
    v_lshlrev_b32 v74, 16, v37
    v_and_b32 v75, 0xffff0000, v37
    s_add_u32 m0, s76, 98304
    s_add_u32 s57, s81, 128
    buffer_load_dwordx4 v22, s[32:35], s57 offen lds
    v_lshlrev_b32 v76, 16, v38
    v_and_b32 v77, 0xffff0000, v38
    v_lshlrev_b32 v78, 16, v39
    v_and_b32 v79, 0xffff0000, v39
    v_lshlrev_b32 v80, 16, v40
    v_and_b32 v81, 0xffff0000, v40
    s_lshl_b32 s81, s65, 7
    s_add_u32 s81, s81, s72
    s_add_u32 m0, s75, 28672
    s_add_u32 s57, s81, 0
    buffer_load_dwordx4 v20, s[28:31], s57 offen lds
    v_lshlrev_b32 v82, 16, v41
    v_and_b32 v83, 0xffff0000, v41
    v_lshlrev_b32 v84, 16, v42
    v_and_b32 v85, 0xffff0000, v42
    v_lshlrev_b32 v86, 16, v43
    v_and_b32 v87, 0xffff0000, v43
    s_add_u32 m0, s75, 29696
    s_add_u32 s57, s81, 8192
    buffer_load_dwordx4 v21, s[28:31], s57 offen lds
    v_lshlrev_b32 v88, 16, v44
    v_and_b32 v89, 0xffff0000, v44
    v_lshlrev_b32 v90, 16, v45
    v_and_b32 v91, 0xffff0000, v45
    s_add_u32 m0, s75, 30720
    s_add_u32 s57, s81, 16384
    buffer_load_dwordx4 v20, s[28:31], s57 offen lds
    s_add_u32 m0, s75, 31744
    s_add_u32 s57, s81, 24576
    buffer_load_dwordx4 v21, s[28:31], s57 offen lds
    s_waitcnt vmcnt(11)
    s_waitcnt lgkmcnt(0)
    s_barrier
    ds_read_b128 a[48:51], v5 offset:49152
    ds_read_b128 a[52:55], v6 offset:49152
    ds_read_b128 a[56:59], v7 offset:49152
    ds_read_b128 a[60:63], v8 offset:49152
    s_mul_i32 s81, s65, 196608
    s_add_u32 s81, s81, s73
    s_add_u32 m0, s76, 102400
    s_add_u32 s57, s81, 0
    buffer_load_dwordx4 v22, s[32:35], s57 offen lds
    v_lshlrev_b32 v92, 16, v46
    v_and_b32 v93, 0xffff0000, v46
    v_lshlrev_b32 v94, 16, v47
    v_and_b32 v95, 0xffff0000, v47
    v_lshlrev_b32 v96, 16, v48
    v_and_b32 v97, 0xffff0000, v48
    s_add_u32 m0, s76, 106496
    s_add_u32 s57, s81, 64
    buffer_load_dwordx4 v22, s[32:35], s57 offen lds
    v_lshlrev_b32 v98, 16, v49
    v_and_b32 v99, 0xffff0000, v49
    v_lshlrev_b32 v100, 16, v50
    v_and_b32 v101, 0xffff0000, v50
    v_lshlrev_b32 v102, 16, v51
    v_and_b32 v103, 0xffff0000, v51
    s_add_u32 m0, s76, 110592
    s_add_u32 s57, s81, 128
    buffer_load_dwordx4 v22, s[32:35], s57 offen lds
    v_lshlrev_b32 v104, 16, v52
    v_and_b32 v105, 0xffff0000, v52
    v_lshlrev_b32 v106, 16, v53
    v_and_b32 v107, 0xffff0000, v53
    v_lshlrev_b32 v108, 16, v54
    v_and_b32 v109, 0xffff0000, v54
    s_lshl_b32 s81, s66, 7
    s_add_u32 s81, s81, s72
    s_add_u32 m0, s75, 45056
    s_add_u32 s57, s81, 0
    buffer_load_dwordx4 v20, s[28:31], s57 offen lds
    v_lshlrev_b32 v110, 16, v55
    v_and_b32 v111, 0xffff0000, v55
    v_lshlrev_b32 v112, 16, v56
    v_and_b32 v113, 0xffff0000, v56
    v_lshlrev_b32 v114, 16, v57
    v_and_b32 v115, 0xffff0000, v57
    s_add_u32 m0, s75, 46080
    s_add_u32 s57, s81, 8192
    buffer_load_dwordx4 v21, s[28:31], s57 offen lds
    v_lshlrev_b32 v116, 16, v58
    v_and_b32 v117, 0xffff0000, v58
    v_lshlrev_b32 v118, 16, v59
    v_and_b32 v119, 0xffff0000, v59
    s_add_u32 m0, s75, 47104
    s_add_u32 s57, s81, 16384
    buffer_load_dwordx4 v20, s[28:31], s57 offen lds
    s_add_u32 m0, s75, 48128
    s_add_u32 s57, s81, 24576
    buffer_load_dwordx4 v21, s[28:31], s57 offen lds
    s_waitcnt vmcnt(11)
    s_waitcnt lgkmcnt(0)
    s_barrier
    ds_read_b128 a[64:67], v5 offset:0
    ds_read_b128 a[68:71], v6 offset:0
    ds_read_b128 a[72:75], v7 offset:0
    ds_read_b128 a[76:79], v8 offset:0
    s_mul_i32 s81, s66, 196608
    s_add_u32 s81, s81, s73
    s_add_u32 m0, s76, 77824
    s_add_u32 s57, s81, 0
    buffer_load_dwordx4 v22, s[32:35], s57 offen lds
    v_mov_b32 v120, 0
    v_mov_b32 v121, 0
    v_mov_b32 v122, 0
    v_mov_b32 v123, 0
    v_mov_b32 v124, 0
    v_mov_b32 v125, 0
    s_add_u32 m0, s76, 81920
    s_add_u32 s57, s81, 64
    buffer_load_dwordx4 v22, s[32:35], s57 offen lds
    v_mov_b32 v126, 0
    v_mov_b32 v127, 0
    s_add_u32 m0, s76, 86016
    s_add_u32 s57, s81, 128
    buffer_load_dwordx4 v22, s[32:35], s57 offen lds
    s_lshl_b32 s81, s67, 7
    s_add_u32 s81, s81, s72
    s_add_u32 m0, s75, 61440
    s_add_u32 s57, s81, 0
    buffer_load_dwordx4 v20, s[28:31], s57 offen lds
    s_add_u32 m0, s75, 62464
    s_add_u32 s57, s81, 8192
    buffer_load_dwordx4 v21, s[28:31], s57 offen lds
    s_add_u32 m0, s75, 63488
    s_add_u32 s57, s81, 16384
    buffer_load_dwordx4 v20, s[28:31], s57 offen lds
    s_add_u32 m0, s75, 64512
    s_add_u32 s57, s81, 24576
    buffer_load_dwordx4 v21, s[28:31], s57 offen lds
    s_mov_b32 exec_lo, -1
    s_mov_b32 exec_hi, 0
    v_add_u32 v18, 0x19000, v24
    ds_write_b16 v18, v25
    s_mov_b64 exec, -1
    s_waitcnt vmcnt(11)
    s_waitcnt lgkmcnt(0)
    s_barrier
    ds_read_b128 a[80:83], v5 offset:16384
    ds_read_b128 a[84:87], v6 offset:16384
    ds_read_b128 a[88:91], v7 offset:16384
    ds_read_b128 a[92:95], v8 offset:16384
    s_mul_i32 s81, s67, 196608
    s_add_u32 s81, s81, s73
    s_add_u32 m0, s76, 90112
    s_add_u32 s57, s81, 0
    buffer_load_dwordx4 v22, s[32:35], s57 offen lds
    s_add_u32 m0, s76, 94208
    s_add_u32 s57, s81, 64
    buffer_load_dwordx4 v22, s[32:35], s57 offen lds
    s_add_u32 m0, s76, 98304
    s_add_u32 s57, s81, 128
    buffer_load_dwordx4 v22, s[32:35], s57 offen lds
    s_mul_i32 s81, s61, 229376
    s_add_u32 s81, s81, s74
    s_add_u32 m0, s76, 131072
    s_add_u32 s57, s81, 0
    buffer_load_dwordx4 v23, s[36:39], s57 offen lds
    s_add_u32 m0, s76, 135168
    s_add_u32 s57, s81, 64
    buffer_load_dwordx4 v23, s[36:39], s57 offen lds
    s_add_u32 m0, s76, 139264
    s_add_u32 s57, s81, 128
    buffer_load_dwordx4 v23, s[36:39], s57 offen lds
    s_add_u32 m0, s76, 143360
    s_add_u32 s57, s81, 192
    s_mov_b64 exec, s[78:79]
    buffer_load_dwordx4 v23, s[36:39], s57 offen lds
    s_mov_b32 exec_lo, -1
    s_mov_b32 exec_hi, 0
    v_add_u32 v18, 0x1d000, v24
    ds_write_b16 v18, v26
    s_mov_b64 exec, -1
    s_waitcnt vmcnt(11)
    s_waitcnt lgkmcnt(0)
    s_barrier
    ds_read_b128 a[96:99], v5 offset:32768
    ds_read_b128 a[100:103], v6 offset:32768
    ds_read_b128 a[104:107], v7 offset:32768
    ds_read_b128 a[108:111], v8 offset:32768
    s_mul_i32 s81, s62, 229376
    s_add_u32 s81, s81, s74
    s_add_u32 m0, s76, 147456
    s_add_u32 s57, s81, 0
    buffer_load_dwordx4 v23, s[36:39], s57 offen lds
    s_add_u32 m0, s76, 151552
    s_add_u32 s57, s81, 64
    buffer_load_dwordx4 v23, s[36:39], s57 offen lds
    s_add_u32 m0, s76, 155648
    s_add_u32 s57, s81, 128
    buffer_load_dwordx4 v23, s[36:39], s57 offen lds
    s_add_u32 m0, s76, 159744
    s_add_u32 s57, s81, 192
    s_mov_b64 exec, s[78:79]
    buffer_load_dwordx4 v23, s[36:39], s57 offen lds
    s_mov_b32 exec_lo, -1
    s_mov_b32 exec_hi, 0
    v_add_u32 v18, 0x21000, v24
    ds_write_b16 v18, v27
    s_mov_b64 exec, -1
    s_mul_i32 s81, s63, 229376
    s_add_u32 s81, s81, s74
    s_add_u32 m0, s76, 12288
    s_add_u32 s57, s81, 0
    buffer_load_dwordx4 v23, s[36:39], s57 offen lds
    s_add_u32 m0, s76, 16384
    s_add_u32 s57, s81, 64
    buffer_load_dwordx4 v23, s[36:39], s57 offen lds
    s_add_u32 m0, s76, 20480
    s_add_u32 s57, s81, 128
    buffer_load_dwordx4 v23, s[36:39], s57 offen lds
    s_add_u32 m0, s76, 24576
    s_add_u32 s57, s81, 192
    s_mov_b64 exec, s[78:79]
    buffer_load_dwordx4 v23, s[36:39], s57 offen lds
    s_mov_b32 exec_lo, -1
    s_mov_b32 exec_hi, 0
    ds_write_b16 v24, v28 offset:0
    s_mov_b64 exec, -1
    s_waitcnt vmcnt(12)
    s_waitcnt vmcnt(8)
    s_waitcnt lgkmcnt(0)
    s_barrier
    ds_read_b128 a[112:115], v5 offset:49152
    ds_read_b128 a[116:119], v6 offset:49152
    ds_read_b128 a[120:123], v7 offset:49152
    ds_read_b128 a[124:127], v8 offset:49152
    s_waitcnt lgkmcnt(0)
    s_mov_b64 exec, 1
    ds_add_u32 v3, v4 offset:8
    s_mov_b64 exec, -1
    s_mul_i32 s81, s64, 229376
    s_add_u32 s81, s81, s74
    s_add_u32 m0, s76, 28672
    s_add_u32 s57, s81, 0
    buffer_load_dwordx4 v23, s[36:39], s57 offen lds
    s_add_u32 m0, s76, 32768
    s_add_u32 s57, s81, 64
    buffer_load_dwordx4 v23, s[36:39], s57 offen lds
    s_add_u32 m0, s76, 36864
    s_add_u32 s57, s81, 128
    buffer_load_dwordx4 v23, s[36:39], s57 offen lds
    s_add_u32 m0, s76, 40960
    s_add_u32 s57, s81, 192
    s_mov_b64 exec, s[78:79]
    buffer_load_dwordx4 v23, s[36:39], s57 offen lds
    s_mov_b32 exec_lo, -1
    s_mov_b32 exec_hi, 0
    ds_write_b16 v24, v29 offset:16384
    s_mov_b64 exec, -1
    s_mul_i32 s81, s65, 229376
    s_add_u32 s81, s81, s74
    s_add_u32 m0, s76, 45056
    s_add_u32 s57, s81, 0
    buffer_load_dwordx4 v23, s[36:39], s57 offen lds
    s_add_u32 m0, s76, 49152
    s_add_u32 s57, s81, 64
    buffer_load_dwordx4 v23, s[36:39], s57 offen lds
    s_add_u32 m0, s76, 53248
    s_add_u32 s57, s81, 128
    buffer_load_dwordx4 v23, s[36:39], s57 offen lds
    s_add_u32 m0, s76, 57344
    s_add_u32 s57, s81, 192
    s_mov_b64 exec, s[78:79]
    buffer_load_dwordx4 v23, s[36:39], s57 offen lds
    s_mov_b32 exec_lo, -1
    s_mov_b32 exec_hi, 0
    ds_write_b16 v24, v30 offset:32768
    s_mov_b64 exec, -1
    ds_read_b64_tr_b16 v[32:33], v10 offset:49152
    ds_read_b64_tr_b16 v[34:35], v10 offset:49408
    ds_read_b64_tr_b16 v[36:37], v10 offset:53248
    ds_read_b64_tr_b16 v[38:39], v10 offset:53504
    ds_read_b64_tr_b16 v[40:41], v10 offset:57344
    ds_read_b64_tr_b16 v[42:43], v10 offset:57600
    ds_read_b64_tr_b16 v[44:45], v10 offset:61440
    ds_read_b64_tr_b16 v[46:47], v10 offset:61696
    ds_read_b64_tr_b16 v[48:49], v10 offset:50176
    ds_read_b64_tr_b16 v[50:51], v10 offset:50432
    ds_read_b64_tr_b16 v[52:53], v10 offset:54272
    ds_read_b64_tr_b16 v[54:55], v10 offset:54528
    ds_read_b64_tr_b16 v[56:57], v10 offset:58368
    ds_read_b64_tr_b16 v[58:59], v10 offset:58624
    ds_read_b64_tr_b16 v[60:61], v10 offset:62464
    ds_read_b64_tr_b16 v[62:63], v10 offset:62720
    s_waitcnt lgkmcnt(12)
    v_mfma_f32_32x32x16_bf16 v[64:79], v[32:35], a[0:3], v[64:79]
    ds_read_b64_tr_b16 v[32:33], v10 offset:51200
    ds_read_b64_tr_b16 v[34:35], v10 offset:51456
    v_mfma_f32_32x32x16_bf16 v[80:95], v[36:39], a[0:3], v[80:95]
    ds_read_b64_tr_b16 v[36:37], v10 offset:55296
    ds_read_b64_tr_b16 v[38:39], v10 offset:55552
    s_waitcnt lgkmcnt(12)
    v_mfma_f32_32x32x16_bf16 v[96:111], v[40:43], a[0:3], v[96:111]
    ds_read_b64_tr_b16 v[40:41], v10 offset:59392
    ds_read_b64_tr_b16 v[42:43], v10 offset:59648
    v_mfma_f32_32x32x16_bf16 v[112:127], v[44:47], a[0:3], v[112:127]
    ds_read_b64_tr_b16 v[44:45], v10 offset:63488
    ds_read_b64_tr_b16 v[46:47], v10 offset:63744
    s_waitcnt lgkmcnt(12)
    v_mfma_f32_32x32x16_bf16 v[64:79], v[48:51], a[4:7], v[64:79]
    ds_read_b64_tr_b16 v[48:49], v10 offset:52224
    ds_read_b64_tr_b16 v[50:51], v10 offset:52480
    v_mfma_f32_32x32x16_bf16 v[80:95], v[52:55], a[4:7], v[80:95]
    ds_read_b64_tr_b16 v[52:53], v10 offset:56320
    ds_read_b64_tr_b16 v[54:55], v10 offset:56576
    s_waitcnt lgkmcnt(12)
    v_mfma_f32_32x32x16_bf16 v[96:111], v[56:59], a[4:7], v[96:111]
    ds_read_b64_tr_b16 v[56:57], v10 offset:60416
    ds_read_b64_tr_b16 v[58:59], v10 offset:60672
    v_mfma_f32_32x32x16_bf16 v[112:127], v[60:63], a[4:7], v[112:127]
    ds_read_b64_tr_b16 v[60:61], v10 offset:64512
    ds_read_b64_tr_b16 v[62:63], v10 offset:64768
    s_waitcnt vmcnt(8)
    s_mov_b64 exec, 1
    ds_add_u32 v3, v4 offset:36
    s_mov_b64 exec, -1
    s_waitcnt lgkmcnt(13)
    v_mfma_f32_32x32x16_bf16 v[64:79], v[32:35], a[8:11], v[64:79]
    ds_read_b64_tr_b16 v[32:33], v11 offset:0
    ds_read_b64_tr_b16 v[34:35], v11 offset:256
    v_mfma_f32_32x32x16_bf16 v[80:95], v[36:39], a[8:11], v[80:95]
    ds_read_b64_tr_b16 v[36:37], v11 offset:4096
    ds_read_b64_tr_b16 v[38:39], v11 offset:4352
    s_waitcnt lgkmcnt(13)
    v_mfma_f32_32x32x16_bf16 v[96:111], v[40:43], a[8:11], v[96:111]
    ds_read_b64_tr_b16 v[40:41], v11 offset:8192
    ds_read_b64_tr_b16 v[42:43], v11 offset:8448
    v_mfma_f32_32x32x16_bf16 v[112:127], v[44:47], a[8:11], v[112:127]
    ds_read_b64_tr_b16 v[44:45], v11 offset:12288
    ds_read_b64_tr_b16 v[46:47], v11 offset:12544
    s_waitcnt lgkmcnt(13)
    v_mfma_f32_32x32x16_bf16 v[64:79], v[48:51], a[12:15], v[64:79]
    ds_read_b64_tr_b16 v[48:49], v11 offset:1024
    ds_read_b64_tr_b16 v[50:51], v11 offset:1280
    v_mfma_f32_32x32x16_bf16 v[80:95], v[52:55], a[12:15], v[80:95]
    ds_read_b64_tr_b16 v[52:53], v11 offset:5120
    ds_read_b64_tr_b16 v[54:55], v11 offset:5376
    s_waitcnt lgkmcnt(13)
    v_mfma_f32_32x32x16_bf16 v[96:111], v[56:59], a[12:15], v[96:111]
    ds_read_b64_tr_b16 v[56:57], v11 offset:9216
    ds_read_b64_tr_b16 v[58:59], v11 offset:9472
    v_mfma_f32_32x32x16_bf16 v[112:127], v[60:63], a[12:15], v[112:127]
    ds_read_b64_tr_b16 v[60:61], v11 offset:13312
    ds_read_b64_tr_b16 v[62:63], v11 offset:13568
    s_waitcnt lgkmcnt(12)
    v_mfma_f32_32x32x16_bf16 v[64:79], v[32:35], a[16:19], v[64:79]
    ds_read_b64_tr_b16 v[32:33], v11 offset:2048
    ds_read_b64_tr_b16 v[34:35], v11 offset:2304
    v_mfma_f32_32x32x16_bf16 v[80:95], v[36:39], a[16:19], v[80:95]
    ds_read_b64_tr_b16 v[36:37], v11 offset:6144
    ds_read_b64_tr_b16 v[38:39], v11 offset:6400
    s_waitcnt lgkmcnt(12)
    v_mfma_f32_32x32x16_bf16 v[96:111], v[40:43], a[16:19], v[96:111]
    ds_read_b64_tr_b16 v[40:41], v11 offset:10240
    ds_read_b64_tr_b16 v[42:43], v11 offset:10496
    v_mfma_f32_32x32x16_bf16 v[112:127], v[44:47], a[16:19], v[112:127]
    ds_read_b64_tr_b16 v[44:45], v11 offset:14336
    ds_read_b64_tr_b16 v[46:47], v11 offset:14592
    s_waitcnt lgkmcnt(12)
    v_mfma_f32_32x32x16_bf16 v[64:79], v[48:51], a[20:23], v[64:79]
    ds_read_b64_tr_b16 v[48:49], v11 offset:3072
    ds_read_b64_tr_b16 v[50:51], v11 offset:3328
    v_mfma_f32_32x32x16_bf16 v[80:95], v[52:55], a[20:23], v[80:95]
    ds_read_b64_tr_b16 v[52:53], v11 offset:7168
    ds_read_b64_tr_b16 v[54:55], v11 offset:7424
    s_waitcnt lgkmcnt(12)
    v_mfma_f32_32x32x16_bf16 v[96:111], v[56:59], a[20:23], v[96:111]
    ds_read_b64_tr_b16 v[56:57], v11 offset:11264
    ds_read_b64_tr_b16 v[58:59], v11 offset:11520
    v_mfma_f32_32x32x16_bf16 v[112:127], v[60:63], a[20:23], v[112:127]
    ds_read_b64_tr_b16 v[60:61], v11 offset:15360
    ds_read_b64_tr_b16 v[62:63], v11 offset:15616
Lw_1:
    ds_read_b32 v12, v3 offset:36
    s_waitcnt lgkmcnt(0)
    v_cmp_gt_u32 vcc, 4, v12
    s_cbranch_vccz Lwd_2
    s_sleep 0
    s_sub_u32 s3, s3, 1
    s_cbranch_scc0 Lw_1
    s_mov_b32 s3, 0
Lwd_2:
    v_mfma_f32_32x32x16_bf16 v[64:79], v[32:35], a[24:27], v[64:79]
    ds_read_b64_tr_b16 v[32:33], v11 offset:16384
    ds_read_b64_tr_b16 v[34:35], v11 offset:16640
    v_mfma_f32_32x32x16_bf16 v[80:95], v[36:39], a[24:27], v[80:95]
    ds_read_b64_tr_b16 v[36:37], v11 offset:20480
    ds_read_b64_tr_b16 v[38:39], v11 offset:20736
    v_mfma_f32_32x32x16_bf16 v[96:111], v[40:43], a[24:27], v[96:111]
    ds_read_b64_tr_b16 v[40:41], v11 offset:24576
    ds_read_b64_tr_b16 v[42:43], v11 offset:24832
    v_mfma_f32_32x32x16_bf16 v[112:127], v[44:47], a[24:27], v[112:127]
    ds_read_b64_tr_b16 v[44:45], v11 offset:28672
    ds_read_b64_tr_b16 v[46:47], v11 offset:28928
    v_mfma_f32_32x32x16_bf16 v[64:79], v[48:51], a[28:31], v[64:79]
    ds_read_b64_tr_b16 v[48:49], v11 offset:17408
    ds_read_b64_tr_b16 v[50:51], v11 offset:17664
    v_mfma_f32_32x32x16_bf16 v[80:95], v[52:55], a[28:31], v[80:95]
    ds_read_b64_tr_b16 v[52:53], v11 offset:21504
    ds_read_b64_tr_b16 v[54:55], v11 offset:21760
    v_mfma_f32_32x32x16_bf16 v[96:111], v[56:59], a[28:31], v[96:111]
    ds_read_b64_tr_b16 v[56:57], v11 offset:25600
    ds_read_b64_tr_b16 v[58:59], v11 offset:25856
    v_mfma_f32_32x32x16_bf16 v[112:127], v[60:63], a[28:31], v[112:127]
    ds_read_b64_tr_b16 v[60:61], v11 offset:29696
    ds_read_b64_tr_b16 v[62:63], v11 offset:29952
    s_waitcnt lgkmcnt(12)
    v_mfma_f32_32x32x16_bf16 v[64:79], v[32:35], a[32:35], v[64:79]
    ds_read_b64_tr_b16 v[32:33], v11 offset:18432
    ds_read_b64_tr_b16 v[34:35], v11 offset:18688
    v_mfma_f32_32x32x16_bf16 v[80:95], v[36:39], a[32:35], v[80:95]
    ds_read_b64_tr_b16 v[36:37], v11 offset:22528
    ds_read_b64_tr_b16 v[38:39], v11 offset:22784
    s_waitcnt lgkmcnt(12)
    v_mfma_f32_32x32x16_bf16 v[96:111], v[40:43], a[32:35], v[96:111]
    ds_read_b64_tr_b16 v[40:41], v11 offset:26624
    ds_read_b64_tr_b16 v[42:43], v11 offset:26880
    v_mfma_f32_32x32x16_bf16 v[112:127], v[44:47], a[32:35], v[112:127]
    ds_read_b64_tr_b16 v[44:45], v11 offset:30720
    ds_read_b64_tr_b16 v[46:47], v11 offset:30976
    s_waitcnt lgkmcnt(12)
    v_mfma_f32_32x32x16_bf16 v[64:79], v[48:51], a[36:39], v[64:79]
    ds_read_b64_tr_b16 v[48:49], v11 offset:19456
    ds_read_b64_tr_b16 v[50:51], v11 offset:19712
    v_mfma_f32_32x32x16_bf16 v[80:95], v[52:55], a[36:39], v[80:95]
    ds_read_b64_tr_b16 v[52:53], v11 offset:23552
    ds_read_b64_tr_b16 v[54:55], v11 offset:23808
    s_waitcnt lgkmcnt(12)
    v_mfma_f32_32x32x16_bf16 v[96:111], v[56:59], a[36:39], v[96:111]
    ds_read_b64_tr_b16 v[56:57], v11 offset:27648
    ds_read_b64_tr_b16 v[58:59], v11 offset:27904
    v_mfma_f32_32x32x16_bf16 v[112:127], v[60:63], a[36:39], v[112:127]
    ds_read_b64_tr_b16 v[60:61], v11 offset:31744
    ds_read_b64_tr_b16 v[62:63], v11 offset:32000
    s_waitcnt vmcnt(0)
    s_mov_b64 exec, 1
    ds_add_u32 v3, v4 offset:36
    s_mov_b64 exec, -1
    s_waitcnt lgkmcnt(13)
    v_mfma_f32_32x32x16_bf16 v[64:79], v[32:35], a[40:43], v[64:79]
    ds_read_b64_tr_b16 v[32:33], v9 offset:12288
    ds_read_b64_tr_b16 v[34:35], v9 offset:12544
    v_mfma_f32_32x32x16_bf16 v[80:95], v[36:39], a[40:43], v[80:95]
    ds_read_b64_tr_b16 v[36:37], v9 offset:16384
    ds_read_b64_tr_b16 v[38:39], v9 offset:16640
    s_waitcnt lgkmcnt(13)
    v_mfma_f32_32x32x16_bf16 v[96:111], v[40:43], a[40:43], v[96:111]
    ds_read_b64_tr_b16 v[40:41], v9 offset:20480
    ds_read_b64_tr_b16 v[42:43], v9 offset:20736
    v_mfma_f32_32x32x16_bf16 v[112:127], v[44:47], a[40:43], v[112:127]
    ds_read_b64_tr_b16 v[44:45], v9 offset:24576
    ds_read_b64_tr_b16 v[46:47], v9 offset:24832
    s_waitcnt lgkmcnt(13)
    v_mfma_f32_32x32x16_bf16 v[64:79], v[48:51], a[44:47], v[64:79]
    ds_read_b64_tr_b16 v[48:49], v9 offset:13312
    ds_read_b64_tr_b16 v[50:51], v9 offset:13568
    v_mfma_f32_32x32x16_bf16 v[80:95], v[52:55], a[44:47], v[80:95]
    ds_read_b64_tr_b16 v[52:53], v9 offset:17408
    ds_read_b64_tr_b16 v[54:55], v9 offset:17664
    s_waitcnt lgkmcnt(13)
    v_mfma_f32_32x32x16_bf16 v[96:111], v[56:59], a[44:47], v[96:111]
    ds_read_b64_tr_b16 v[56:57], v9 offset:21504
    ds_read_b64_tr_b16 v[58:59], v9 offset:21760
    v_mfma_f32_32x32x16_bf16 v[112:127], v[60:63], a[44:47], v[112:127]
    ds_read_b64_tr_b16 v[60:61], v9 offset:25600
    ds_read_b64_tr_b16 v[62:63], v9 offset:25856
    s_waitcnt lgkmcnt(12)
    v_mfma_f32_32x32x16_bf16 v[64:79], v[32:35], a[48:51], v[64:79]
    ds_read_b64_tr_b16 v[32:33], v9 offset:14336
    ds_read_b64_tr_b16 v[34:35], v9 offset:14592
    v_mfma_f32_32x32x16_bf16 v[80:95], v[36:39], a[48:51], v[80:95]
    ds_read_b64_tr_b16 v[36:37], v9 offset:18432
    ds_read_b64_tr_b16 v[38:39], v9 offset:18688
    s_waitcnt lgkmcnt(12)
    v_mfma_f32_32x32x16_bf16 v[96:111], v[40:43], a[48:51], v[96:111]
    ds_read_b64_tr_b16 v[40:41], v9 offset:22528
    ds_read_b64_tr_b16 v[42:43], v9 offset:22784
    v_mfma_f32_32x32x16_bf16 v[112:127], v[44:47], a[48:51], v[112:127]
    ds_read_b64_tr_b16 v[44:45], v9 offset:26624
    ds_read_b64_tr_b16 v[46:47], v9 offset:26880
    s_waitcnt lgkmcnt(12)
    v_mfma_f32_32x32x16_bf16 v[64:79], v[48:51], a[52:55], v[64:79]
    ds_read_b64_tr_b16 v[48:49], v9 offset:15360
    ds_read_b64_tr_b16 v[50:51], v9 offset:15616
    v_mfma_f32_32x32x16_bf16 v[80:95], v[52:55], a[52:55], v[80:95]
    ds_read_b64_tr_b16 v[52:53], v9 offset:19456
    ds_read_b64_tr_b16 v[54:55], v9 offset:19712
    s_waitcnt lgkmcnt(12)
    v_mfma_f32_32x32x16_bf16 v[96:111], v[56:59], a[52:55], v[96:111]
    ds_read_b64_tr_b16 v[56:57], v9 offset:23552
    ds_read_b64_tr_b16 v[58:59], v9 offset:23808
    v_mfma_f32_32x32x16_bf16 v[112:127], v[60:63], a[52:55], v[112:127]
    ds_read_b64_tr_b16 v[60:61], v9 offset:27648
    ds_read_b64_tr_b16 v[62:63], v9 offset:27904
Lw_3:
    ds_read_b32 v12, v3 offset:36
    s_waitcnt lgkmcnt(0)
    v_cmp_gt_u32 vcc, 8, v12
    s_cbranch_vccz Lwd_4
    s_sleep 0
    s_sub_u32 s3, s3, 1
    s_cbranch_scc0 Lw_3
    s_mov_b32 s3, 0
Lwd_4:
    v_mfma_f32_32x32x16_bf16 v[64:79], v[32:35], a[56:59], v[64:79]
    ds_read_b64_tr_b16 v[32:33], v9 offset:28672
    ds_read_b64_tr_b16 v[34:35], v9 offset:28928
    v_mfma_f32_32x32x16_bf16 v[80:95], v[36:39], a[56:59], v[80:95]
    ds_read_b64_tr_b16 v[36:37], v9 offset:32768
    ds_read_b64_tr_b16 v[38:39], v9 offset:33024
    v_mfma_f32_32x32x16_bf16 v[96:111], v[40:43], a[56:59], v[96:111]
    ds_read_b64_tr_b16 v[40:41], v9 offset:36864
    ds_read_b64_tr_b16 v[42:43], v9 offset:37120
    v_mfma_f32_32x32x16_bf16 v[112:127], v[44:47], a[56:59], v[112:127]
    ds_read_b64_tr_b16 v[44:45], v9 offset:40960
    ds_read_b64_tr_b16 v[46:47], v9 offset:41216
    v_mfma_f32_32x32x16_bf16 v[64:79], v[48:51], a[60:63], v[64:79]
    ds_read_b64_tr_b16 v[48:49], v9 offset:29696
    ds_read_b64_tr_b16 v[50:51], v9 offset:29952
    v_mfma_f32_32x32x16_bf16 v[80:95], v[52:55], a[60:63], v[80:95]
    ds_read_b64_tr_b16 v[52:53], v9 offset:33792
    ds_read_b64_tr_b16 v[54:55], v9 offset:34048
    v_mfma_f32_32x32x16_bf16 v[96:111], v[56:59], a[60:63], v[96:111]
    ds_read_b64_tr_b16 v[56:57], v9 offset:37888
    ds_read_b64_tr_b16 v[58:59], v9 offset:38144
    v_mfma_f32_32x32x16_bf16 v[112:127], v[60:63], a[60:63], v[112:127]
    ds_read_b64_tr_b16 v[60:61], v9 offset:41984
    ds_read_b64_tr_b16 v[62:63], v9 offset:42240
    s_waitcnt lgkmcnt(12)
    v_mfma_f32_32x32x16_bf16 v[64:79], v[32:35], a[64:67], v[64:79]
    ds_read_b64_tr_b16 v[32:33], v9 offset:30720
    ds_read_b64_tr_b16 v[34:35], v9 offset:30976
    v_mfma_f32_32x32x16_bf16 v[80:95], v[36:39], a[64:67], v[80:95]
    ds_read_b64_tr_b16 v[36:37], v9 offset:34816
    ds_read_b64_tr_b16 v[38:39], v9 offset:35072
    s_waitcnt lgkmcnt(12)
    v_mfma_f32_32x32x16_bf16 v[96:111], v[40:43], a[64:67], v[96:111]
    ds_read_b64_tr_b16 v[40:41], v9 offset:38912
    ds_read_b64_tr_b16 v[42:43], v9 offset:39168
    v_mfma_f32_32x32x16_bf16 v[112:127], v[44:47], a[64:67], v[112:127]
    ds_read_b64_tr_b16 v[44:45], v9 offset:43008
    ds_read_b64_tr_b16 v[46:47], v9 offset:43264
    s_waitcnt lgkmcnt(12)
    v_mfma_f32_32x32x16_bf16 v[64:79], v[48:51], a[68:71], v[64:79]
    ds_read_b64_tr_b16 v[48:49], v9 offset:31744
    ds_read_b64_tr_b16 v[50:51], v9 offset:32000
    v_mfma_f32_32x32x16_bf16 v[80:95], v[52:55], a[68:71], v[80:95]
    ds_read_b64_tr_b16 v[52:53], v9 offset:35840
    ds_read_b64_tr_b16 v[54:55], v9 offset:36096
    s_waitcnt lgkmcnt(12)
    v_mfma_f32_32x32x16_bf16 v[96:111], v[56:59], a[68:71], v[96:111]
    ds_read_b64_tr_b16 v[56:57], v9 offset:39936
    ds_read_b64_tr_b16 v[58:59], v9 offset:40192
    v_mfma_f32_32x32x16_bf16 v[112:127], v[60:63], a[68:71], v[112:127]
    ds_read_b64_tr_b16 v[60:61], v9 offset:44032
    ds_read_b64_tr_b16 v[62:63], v9 offset:44288
    s_waitcnt lgkmcnt(12)
    v_mfma_f32_32x32x16_bf16 v[64:79], v[32:35], a[72:75], v[64:79]
    ds_read_b64_tr_b16 v[32:33], v9 offset:45056
    ds_read_b64_tr_b16 v[34:35], v9 offset:45312
    v_mfma_f32_32x32x16_bf16 v[80:95], v[36:39], a[72:75], v[80:95]
    ds_read_b64_tr_b16 v[36:37], v9 offset:49152
    ds_read_b64_tr_b16 v[38:39], v9 offset:49408
    s_waitcnt lgkmcnt(12)
    v_mfma_f32_32x32x16_bf16 v[96:111], v[40:43], a[72:75], v[96:111]
    ds_read_b64_tr_b16 v[40:41], v9 offset:53248
    ds_read_b64_tr_b16 v[42:43], v9 offset:53504
    v_mfma_f32_32x32x16_bf16 v[112:127], v[44:47], a[72:75], v[112:127]
    ds_read_b64_tr_b16 v[44:45], v9 offset:57344
    ds_read_b64_tr_b16 v[46:47], v9 offset:57600
    s_waitcnt lgkmcnt(12)
    v_mfma_f32_32x32x16_bf16 v[64:79], v[48:51], a[76:79], v[64:79]
    ds_read_b64_tr_b16 v[48:49], v9 offset:46080
    ds_read_b64_tr_b16 v[50:51], v9 offset:46336
    v_mfma_f32_32x32x16_bf16 v[80:95], v[52:55], a[76:79], v[80:95]
    ds_read_b64_tr_b16 v[52:53], v9 offset:50176
    ds_read_b64_tr_b16 v[54:55], v9 offset:50432
    s_waitcnt lgkmcnt(12)
    v_mfma_f32_32x32x16_bf16 v[96:111], v[56:59], a[76:79], v[96:111]
    ds_read_b64_tr_b16 v[56:57], v9 offset:54272
    ds_read_b64_tr_b16 v[58:59], v9 offset:54528
    v_mfma_f32_32x32x16_bf16 v[112:127], v[60:63], a[76:79], v[112:127]
    ds_read_b64_tr_b16 v[60:61], v9 offset:58368
    ds_read_b64_tr_b16 v[62:63], v9 offset:58624
    s_mov_b64 exec, 1
    ds_add_u32 v3, v4 offset:40
    s_mov_b64 exec, -1
    s_waitcnt lgkmcnt(13)
    v_mfma_f32_32x32x16_bf16 v[64:79], v[32:35], a[80:83], v[64:79]
    ds_read_b64_tr_b16 v[32:33], v9 offset:47104
    ds_read_b64_tr_b16 v[34:35], v9 offset:47360
    v_mfma_f32_32x32x16_bf16 v[80:95], v[36:39], a[80:83], v[80:95]
    ds_read_b64_tr_b16 v[36:37], v9 offset:51200
    ds_read_b64_tr_b16 v[38:39], v9 offset:51456
    s_waitcnt lgkmcnt(13)
    v_mfma_f32_32x32x16_bf16 v[96:111], v[40:43], a[80:83], v[96:111]
    ds_read_b64_tr_b16 v[40:41], v9 offset:55296
    ds_read_b64_tr_b16 v[42:43], v9 offset:55552
    v_mfma_f32_32x32x16_bf16 v[112:127], v[44:47], a[80:83], v[112:127]
    ds_read_b64_tr_b16 v[44:45], v9 offset:59392
    ds_read_b64_tr_b16 v[46:47], v9 offset:59648
    s_waitcnt lgkmcnt(13)
    v_mfma_f32_32x32x16_bf16 v[64:79], v[48:51], a[84:87], v[64:79]
    ds_read_b64_tr_b16 v[48:49], v9 offset:48128
    ds_read_b64_tr_b16 v[50:51], v9 offset:48384
    v_mfma_f32_32x32x16_bf16 v[80:95], v[52:55], a[84:87], v[80:95]
    ds_read_b64_tr_b16 v[52:53], v9 offset:52224
    ds_read_b64_tr_b16 v[54:55], v9 offset:52480
    s_waitcnt lgkmcnt(13)
    v_mfma_f32_32x32x16_bf16 v[96:111], v[56:59], a[84:87], v[96:111]
    ds_read_b64_tr_b16 v[56:57], v9 offset:56320
    ds_read_b64_tr_b16 v[58:59], v9 offset:56576
    v_mfma_f32_32x32x16_bf16 v[112:127], v[60:63], a[84:87], v[112:127]
    ds_read_b64_tr_b16 v[60:61], v9 offset:60416
    ds_read_b64_tr_b16 v[62:63], v9 offset:60672
Lw_5:
    ds_read_b32 v12, v3 offset:56
    s_waitcnt lgkmcnt(0)
    v_cmp_gt_u32 vcc, 4, v12
    s_cbranch_vccz Lwd_6
    s_sleep 0
    s_sub_u32 s3, s3, 1
    s_cbranch_scc0 Lw_5
    s_mov_b32 s3, 0
Lwd_6:
    v_mfma_f32_32x32x16_bf16 v[64:79], v[32:35], a[88:91], v[64:79]
    ds_read_b64_tr_b16 v[32:33], v9 offset:61440
    ds_read_b64_tr_b16 v[34:35], v9 offset:61696
    v_mfma_f32_32x32x16_bf16 v[80:95], v[36:39], a[88:91], v[80:95]
    ds_read_b64_tr_b16 v[36:37], v10 offset:0
    ds_read_b64_tr_b16 v[38:39], v10 offset:256
    v_mfma_f32_32x32x16_bf16 v[96:111], v[40:43], a[88:91], v[96:111]
    ds_read_b64_tr_b16 v[40:41], v10 offset:4096
    ds_read_b64_tr_b16 v[42:43], v10 offset:4352
    v_mfma_f32_32x32x16_bf16 v[112:127], v[44:47], a[88:91], v[112:127]
    ds_read_b64_tr_b16 v[44:45], v10 offset:8192
    ds_read_b64_tr_b16 v[46:47], v10 offset:8448
    v_mfma_f32_32x32x16_bf16 v[64:79], v[48:51], a[92:95], v[64:79]
    ds_read_b64_tr_b16 v[48:49], v9 offset:62464
    ds_read_b64_tr_b16 v[50:51], v9 offset:62720
    v_mfma_f32_32x32x16_bf16 v[80:95], v[52:55], a[92:95], v[80:95]
    ds_read_b64_tr_b16 v[52:53], v10 offset:1024
    ds_read_b64_tr_b16 v[54:55], v10 offset:1280
    v_mfma_f32_32x32x16_bf16 v[96:111], v[56:59], a[92:95], v[96:111]
    ds_read_b64_tr_b16 v[56:57], v10 offset:5120
    ds_read_b64_tr_b16 v[58:59], v10 offset:5376
    v_mfma_f32_32x32x16_bf16 v[112:127], v[60:63], a[92:95], v[112:127]
    ds_read_b64_tr_b16 v[60:61], v10 offset:9216
    ds_read_b64_tr_b16 v[62:63], v10 offset:9472
    s_waitcnt lgkmcnt(12)
    v_mfma_f32_32x32x16_bf16 v[64:79], v[32:35], a[96:99], v[64:79]
    ds_read_b64_tr_b16 v[32:33], v9 offset:63488
    ds_read_b64_tr_b16 v[34:35], v9 offset:63744
    v_mfma_f32_32x32x16_bf16 v[80:95], v[36:39], a[96:99], v[80:95]
    ds_read_b64_tr_b16 v[36:37], v10 offset:2048
    ds_read_b64_tr_b16 v[38:39], v10 offset:2304
    s_waitcnt lgkmcnt(12)
    v_mfma_f32_32x32x16_bf16 v[96:111], v[40:43], a[96:99], v[96:111]
    ds_read_b64_tr_b16 v[40:41], v10 offset:6144
    ds_read_b64_tr_b16 v[42:43], v10 offset:6400
    v_mfma_f32_32x32x16_bf16 v[112:127], v[44:47], a[96:99], v[112:127]
    ds_read_b64_tr_b16 v[44:45], v10 offset:10240
    ds_read_b64_tr_b16 v[46:47], v10 offset:10496
    s_waitcnt lgkmcnt(12)
    v_mfma_f32_32x32x16_bf16 v[64:79], v[48:51], a[100:103], v[64:79]
    ds_read_b64_tr_b16 v[48:49], v9 offset:64512
    ds_read_b64_tr_b16 v[50:51], v9 offset:64768
    v_mfma_f32_32x32x16_bf16 v[80:95], v[52:55], a[100:103], v[80:95]
    ds_read_b64_tr_b16 v[52:53], v10 offset:3072
    ds_read_b64_tr_b16 v[54:55], v10 offset:3328
    s_waitcnt lgkmcnt(12)
    v_mfma_f32_32x32x16_bf16 v[96:111], v[56:59], a[100:103], v[96:111]
    ds_read_b64_tr_b16 v[56:57], v10 offset:7168
    ds_read_b64_tr_b16 v[58:59], v10 offset:7424
    v_mfma_f32_32x32x16_bf16 v[112:127], v[60:63], a[100:103], v[112:127]
    ds_read_b64_tr_b16 v[60:61], v10 offset:11264
    ds_read_b64_tr_b16 v[62:63], v10 offset:11520
    s_waitcnt lgkmcnt(12)
    v_mfma_f32_32x32x16_bf16 v[64:79], v[32:35], a[104:107], v[64:79]
    ds_read_b64_tr_b16 v[32:33], v10 offset:12288
    ds_read_b64_tr_b16 v[34:35], v10 offset:12544
    v_mfma_f32_32x32x16_bf16 v[80:95], v[36:39], a[104:107], v[80:95]
    ds_read_b64_tr_b16 v[36:37], v10 offset:16384
    ds_read_b64_tr_b16 v[38:39], v10 offset:16640
    s_waitcnt lgkmcnt(12)
    v_mfma_f32_32x32x16_bf16 v[96:111], v[40:43], a[104:107], v[96:111]
    ds_read_b64_tr_b16 v[40:41], v10 offset:20480
    ds_read_b64_tr_b16 v[42:43], v10 offset:20736
    v_mfma_f32_32x32x16_bf16 v[112:127], v[44:47], a[104:107], v[112:127]
    ds_read_b64_tr_b16 v[44:45], v10 offset:24576
    ds_read_b64_tr_b16 v[46:47], v10 offset:24832
    s_waitcnt lgkmcnt(12)
    v_mfma_f32_32x32x16_bf16 v[64:79], v[48:51], a[108:111], v[64:79]
    ds_read_b64_tr_b16 v[48:49], v10 offset:13312
    ds_read_b64_tr_b16 v[50:51], v10 offset:13568
    v_mfma_f32_32x32x16_bf16 v[80:95], v[52:55], a[108:111], v[80:95]
    ds_read_b64_tr_b16 v[52:53], v10 offset:17408
    ds_read_b64_tr_b16 v[54:55], v10 offset:17664
    s_waitcnt lgkmcnt(12)
    v_mfma_f32_32x32x16_bf16 v[96:111], v[56:59], a[108:111], v[96:111]
    ds_read_b64_tr_b16 v[56:57], v10 offset:21504
    ds_read_b64_tr_b16 v[58:59], v10 offset:21760
    v_mfma_f32_32x32x16_bf16 v[112:127], v[60:63], a[108:111], v[112:127]
    ds_read_b64_tr_b16 v[60:61], v10 offset:25600
    ds_read_b64_tr_b16 v[62:63], v10 offset:25856
    s_waitcnt lgkmcnt(12)
    v_mfma_f32_32x32x16_bf16 v[64:79], v[32:35], a[112:115], v[64:79]
    ds_read_b64_tr_b16 v[32:33], v10 offset:14336
    ds_read_b64_tr_b16 v[34:35], v10 offset:14592
    v_mfma_f32_32x32x16_bf16 v[80:95], v[36:39], a[112:115], v[80:95]
    ds_read_b64_tr_b16 v[36:37], v10 offset:18432
    ds_read_b64_tr_b16 v[38:39], v10 offset:18688
    s_waitcnt lgkmcnt(12)
    v_mfma_f32_32x32x16_bf16 v[96:111], v[40:43], a[112:115], v[96:111]
    ds_read_b64_tr_b16 v[40:41], v10 offset:22528
    ds_read_b64_tr_b16 v[42:43], v10 offset:22784
    v_mfma_f32_32x32x16_bf16 v[112:127], v[44:47], a[112:115], v[112:127]
    ds_read_b64_tr_b16 v[44:45], v10 offset:26624
    ds_read_b64_tr_b16 v[46:47], v10 offset:26880
    s_waitcnt lgkmcnt(12)
    v_mfma_f32_32x32x16_bf16 v[64:79], v[48:51], a[116:119], v[64:79]
    ds_read_b64_tr_b16 v[48:49], v10 offset:15360
    ds_read_b64_tr_b16 v[50:51], v10 offset:15616
    v_mfma_f32_32x32x16_bf16 v[80:95], v[52:55], a[116:119], v[80:95]
    ds_read_b64_tr_b16 v[52:53], v10 offset:19456
    ds_read_b64_tr_b16 v[54:55], v10 offset:19712
    s_waitcnt lgkmcnt(12)
    v_mfma_f32_32x32x16_bf16 v[96:111], v[56:59], a[116:119], v[96:111]
    ds_read_b64_tr_b16 v[56:57], v10 offset:23552
    ds_read_b64_tr_b16 v[58:59], v10 offset:23808
    v_mfma_f32_32x32x16_bf16 v[112:127], v[60:63], a[116:119], v[112:127]
    ds_read_b64_tr_b16 v[60:61], v10 offset:27648
    ds_read_b64_tr_b16 v[62:63], v10 offset:27904
    s_waitcnt lgkmcnt(12)
    v_mfma_f32_32x32x16_bf16 v[64:79], v[32:35], a[120:123], v[64:79]
    v_mfma_f32_32x32x16_bf16 v[80:95], v[36:39], a[120:123], v[80:95]
    s_waitcnt lgkmcnt(8)
    v_mfma_f32_32x32x16_bf16 v[96:111], v[40:43], a[120:123], v[96:111]
    v_mfma_f32_32x32x16_bf16 v[112:127], v[44:47], a[120:123], v[112:127]
    s_waitcnt lgkmcnt(4)
    v_mfma_f32_32x32x16_bf16 v[64:79], v[48:51], a[124:127], v[64:79]
    v_mfma_f32_32x32x16_bf16 v[80:95], v[52:55], a[124:127], v[80:95]
    s_waitcnt lgkmcnt(0)
    v_mfma_f32_32x32x16_bf16 v[96:111], v[56:59], a[124:127], v[96:111]
    v_mfma_f32_32x32x16_bf16 v[112:127], v[60:63], a[124:127], v[112:127]
    v_mov_b32 v28, 0xc0135761
    v_mov_b32 v29, 0xc0135761
    v_mov_b32 v30, 0xbdd2d3e8
    v_mov_b32 v31, 0xbdd2d3e8
    s_mul_i32 s80, s55, 114688
    s_mul_i32 s57, s53, 7168
    s_add_u32 s80, s80, s57
    s_add_u32 s80, s80, 0x600000
    s_add_u32 s81, s80, 4096
    s_lshr_b32 s56, s68, 1
    s_add_u32 s57, s56, 16
    s_mul_i32 s57, s57, 43
    s_lshr_b32 s57, s57, 7
    s_lshl_b32 s57, s57, 6
    s_add_u32 s58, s56, 32
    s_mul_i32 s58, s58, 43
    s_lshr_b32 s58, s58, 7
    s_lshl_b32 s58, s58, 6
    s_mul_i32 s56, s56, 43
    s_lshr_b32 s56, s56, 7
    s_lshl_b32 s56, s56, 6
    v_and_b32 v16, 15, v1
    v_lshl_add_u32 v16, v16, 2, s52
    v_add_u32 v16, 20, v16
    v_min_u32 v16, 63, v16
    v_add_u32 v17, s57, v16
    v_add_u32 v18, s58, v16
    v_and_b32 v16, 16, v1
    v_cmp_eq_u32 vcc, 0, v16
    s_nop 1
    v_cndmask_b32 v17, v18, v17, vcc
    v_lshlrev_b32 v24, 8, v17
    s_mov_b64 exec, 1
    ds_add_u32 v3, v4 offset:12
    s_mov_b64 exec, -1
    v_mul_f32 v25, 0x3fb8aa3b, v120
    v_exp_f32 v26, v25
    v_exp_f32 v25, -v25
    v_add_f32 v26, 1.0, v26
    v_add_f32 v25, 1.0, v25
    v_min_f32 v26, 0x7b800000, v26
    v_rcp_f32 v25, v25
    v_mov_b32 v27, v26
    v_pk_mul_f32 v[32:33], v[64:65], v[64:65]
    v_pk_mul_f32 v[34:35], v[66:67], v[66:67]
    v_pk_mul_f32 v[36:37], v[68:69], v[68:69]
    v_pk_mul_f32 v[38:39], v[70:71], v[70:71]
    v_pk_fma_f32 v[32:33], v[32:33], v[30:31], v[28:29]
    v_pk_fma_f32 v[34:35], v[34:35], v[30:31], v[28:29]
    v_pk_fma_f32 v[36:37], v[36:37], v[30:31], v[28:29]
    v_pk_fma_f32 v[38:39], v[38:39], v[30:31], v[28:29]
    v_pk_mul_f32 v[32:33], v[32:33], v[64:65]
    v_pk_mul_f32 v[34:35], v[34:35], v[66:67]
    v_pk_mul_f32 v[36:37], v[36:37], v[68:69]
    v_pk_mul_f32 v[38:39], v[38:39], v[70:71]
    v_exp_f32 v32, v32
    v_exp_f32 v33, v33
    v_exp_f32 v34, v34
    v_exp_f32 v35, v35
    v_exp_f32 v36, v36
    v_exp_f32 v37, v37
    v_exp_f32 v38, v38
    v_exp_f32 v39, v39
    v_pk_fma_f32 v[32:33], v[32:33], v[26:27], v[26:27]
    v_pk_fma_f32 v[34:35], v[34:35], v[26:27], v[26:27]
    v_pk_fma_f32 v[36:37], v[36:37], v[26:27], v[26:27]
    v_pk_fma_f32 v[38:39], v[38:39], v[26:27], v[26:27]
    v_rcp_f32 v32, v32
    v_rcp_f32 v33, v33
    v_rcp_f32 v34, v34
    v_rcp_f32 v35, v35
    v_rcp_f32 v36, v36
    v_rcp_f32 v37, v37
    v_rcp_f32 v38, v38
    v_rcp_f32 v39, v39
    v_pk_mul_f32 v[32:33], v[32:33], v[64:65]
    v_pk_mul_f32 v[34:35], v[34:35], v[66:67]
    v_pk_mul_f32 v[36:37], v[36:37], v[68:69]
    v_pk_mul_f32 v[38:39], v[38:39], v[70:71]
    v_cvt_pk_bf16_f32 v64, v32, v33
    v_cvt_pk_bf16_f32 v65, v34, v35
    v_cvt_pk_bf16_f32 v66, v36, v37
    v_cvt_pk_bf16_f32 v67, v38, v39
    v_pk_mul_f32 v[40:41], v[72:73], v[72:73]
    v_pk_mul_f32 v[42:43], v[74:75], v[74:75]
    v_pk_mul_f32 v[44:45], v[76:77], v[76:77]
    v_pk_mul_f32 v[46:47], v[78:79], v[78:79]
    v_pk_fma_f32 v[40:41], v[40:41], v[30:31], v[28:29]
    v_pk_fma_f32 v[42:43], v[42:43], v[30:31], v[28:29]
    v_pk_fma_f32 v[44:45], v[44:45], v[30:31], v[28:29]
    v_pk_fma_f32 v[46:47], v[46:47], v[30:31], v[28:29]
    v_pk_mul_f32 v[40:41], v[40:41], v[72:73]
    v_pk_mul_f32 v[42:43], v[42:43], v[74:75]
    v_pk_mul_f32 v[44:45], v[44:45], v[76:77]
    v_pk_mul_f32 v[46:47], v[46:47], v[78:79]
    v_exp_f32 v40, v40
    v_exp_f32 v41, v41
    v_exp_f32 v42, v42
    v_exp_f32 v43, v43
    v_exp_f32 v44, v44
    v_exp_f32 v45, v45
    v_exp_f32 v46, v46
    v_exp_f32 v47, v47
    v_pk_fma_f32 v[40:41], v[40:41], v[26:27], v[26:27]
    v_pk_fma_f32 v[42:43], v[42:43], v[26:27], v[26:27]
    v_pk_fma_f32 v[44:45], v[44:45], v[26:27], v[26:27]
    v_pk_fma_f32 v[46:47], v[46:47], v[26:27], v[26:27]
    v_rcp_f32 v40, v40
    v_rcp_f32 v41, v41
    v_rcp_f32 v42, v42
    v_rcp_f32 v43, v43
    v_rcp_f32 v44, v44
    v_rcp_f32 v45, v45
    v_rcp_f32 v46, v46
    v_rcp_f32 v47, v47
    v_pk_mul_f32 v[40:41], v[40:41], v[72:73]
    v_pk_mul_f32 v[42:43], v[42:43], v[74:75]
    v_pk_mul_f32 v[44:45], v[44:45], v[76:77]
    v_pk_mul_f32 v[46:47], v[46:47], v[78:79]
    v_cvt_pk_bf16_f32 v72, v40, v41
    v_cvt_pk_bf16_f32 v73, v42, v43
    v_cvt_pk_bf16_f32 v74, v44, v45
    v_cvt_pk_bf16_f32 v75, v46, v47
    v_pk_mul_f32 v[32:33], v[80:81], v[80:81]
    v_pk_mul_f32 v[34:35], v[82:83], v[82:83]
    v_pk_mul_f32 v[36:37], v[84:85], v[84:85]
    v_pk_mul_f32 v[38:39], v[86:87], v[86:87]
    v_pk_fma_f32 v[32:33], v[32:33], v[30:31], v[28:29]
    v_pk_fma_f32 v[34:35], v[34:35], v[30:31], v[28:29]
    v_pk_fma_f32 v[36:37], v[36:37], v[30:31], v[28:29]
    v_pk_fma_f32 v[38:39], v[38:39], v[30:31], v[28:29]
    v_pk_mul_f32 v[32:33], v[32:33], v[80:81]
    v_pk_mul_f32 v[34:35], v[34:35], v[82:83]
    v_pk_mul_f32 v[36:37], v[36:37], v[84:85]
    v_pk_mul_f32 v[38:39], v[38:39], v[86:87]
    v_exp_f32 v32, v32
    v_exp_f32 v33, v33
    v_exp_f32 v34, v34
    v_exp_f32 v35, v35
    v_exp_f32 v36, v36
    v_exp_f32 v37, v37
    v_exp_f32 v38, v38
    v_exp_f32 v39, v39
    v_pk_fma_f32 v[32:33], v[32:33], v[26:27], v[26:27]
    v_pk_fma_f32 v[34:35], v[34:35], v[26:27], v[26:27]
    v_pk_fma_f32 v[36:37], v[36:37], v[26:27], v[26:27]
    v_pk_fma_f32 v[38:39], v[38:39], v[26:27], v[26:27]
    v_rcp_f32 v32, v32
    v_rcp_f32 v33, v33
    v_rcp_f32 v34, v34
    v_rcp_f32 v35, v35
    v_rcp_f32 v36, v36
    v_rcp_f32 v37, v37
    v_rcp_f32 v38, v38
    v_rcp_f32 v39, v39
    v_pk_mul_f32 v[32:33], v[32:33], v[80:81]
    v_pk_mul_f32 v[34:35], v[34:35], v[82:83]
    v_pk_mul_f32 v[36:37], v[36:37], v[84:85]
    v_pk_mul_f32 v[38:39], v[38:39], v[86:87]
    v_cvt_pk_bf16_f32 v80, v32, v33
    v_cvt_pk_bf16_f32 v81, v34, v35
    v_cvt_pk_bf16_f32 v82, v36, v37
    v_cvt_pk_bf16_f32 v83, v38, v39
    v_pk_mul_f32 v[40:41], v[88:89], v[88:89]
    v_pk_mul_f32 v[42:43], v[90:91], v[90:91]
    v_pk_mul_f32 v[44:45], v[92:93], v[92:93]
    v_pk_mul_f32 v[46:47], v[94:95], v[94:95]
    v_pk_fma_f32 v[40:41], v[40:41], v[30:31], v[28:29]
    v_pk_fma_f32 v[42:43], v[42:43], v[30:31], v[28:29]
    v_pk_fma_f32 v[44:45], v[44:45], v[30:31], v[28:29]
    v_pk_fma_f32 v[46:47], v[46:47], v[30:31], v[28:29]
    v_pk_mul_f32 v[40:41], v[40:41], v[88:89]
    v_pk_mul_f32 v[42:43], v[42:43], v[90:91]
    v_pk_mul_f32 v[44:45], v[44:45], v[92:93]
    v_pk_mul_f32 v[46:47], v[46:47], v[94:95]
    v_exp_f32 v40, v40
    v_exp_f32 v41, v41
    v_exp_f32 v42, v42
    v_exp_f32 v43, v43
    v_exp_f32 v44, v44
    v_exp_f32 v45, v45
    v_exp_f32 v46, v46
    v_exp_f32 v47, v47
    v_pk_fma_f32 v[40:41], v[40:41], v[26:27], v[26:27]
    v_pk_fma_f32 v[42:43], v[42:43], v[26:27], v[26:27]
    v_pk_fma_f32 v[44:45], v[44:45], v[26:27], v[26:27]
    v_pk_fma_f32 v[46:47], v[46:47], v[26:27], v[26:27]
    v_rcp_f32 v40, v40
    v_rcp_f32 v41, v41
    v_rcp_f32 v42, v42
    v_rcp_f32 v43, v43
    v_rcp_f32 v44, v44
    v_rcp_f32 v45, v45
    v_rcp_f32 v46, v46
    v_rcp_f32 v47, v47
    v_pk_mul_f32 v[40:41], v[40:41], v[88:89]
    v_pk_mul_f32 v[42:43], v[42:43], v[90:91]
    v_pk_mul_f32 v[44:45], v[44:45], v[92:93]
    v_pk_mul_f32 v[46:47], v[46:47], v[94:95]
    v_cvt_pk_bf16_f32 v88, v40, v41
    v_cvt_pk_bf16_f32 v89, v42, v43
    v_cvt_pk_bf16_f32 v90, v44, v45
    v_cvt_pk_bf16_f32 v91, v46, v47
    v_pk_mul_f32 v[32:33], v[96:97], v[96:97]
    v_pk_mul_f32 v[34:35], v[98:99], v[98:99]
    v_pk_mul_f32 v[36:37], v[100:101], v[100:101]
    v_pk_mul_f32 v[38:39], v[102:103], v[102:103]
    v_pk_fma_f32 v[32:33], v[32:33], v[30:31], v[28:29]
    v_pk_fma_f32 v[34:35], v[34:35], v[30:31], v[28:29]
    v_pk_fma_f32 v[36:37], v[36:37], v[30:31], v[28:29]
    v_pk_fma_f32 v[38:39], v[38:39], v[30:31], v[28:29]
    v_pk_mul_f32 v[32:33], v[32:33], v[96:97]
    v_pk_mul_f32 v[34:35], v[34:35], v[98:99]
    v_pk_mul_f32 v[36:37], v[36:37], v[100:101]
    v_pk_mul_f32 v[38:39], v[38:39], v[102:103]
    v_exp_f32 v32, v32
    v_exp_f32 v33, v33
    v_exp_f32 v34, v34
    v_exp_f32 v35, v35
    v_exp_f32 v36, v36
    v_exp_f32 v37, v37
    v_exp_f32 v38, v38
    v_exp_f32 v39, v39
    v_pk_fma_f32 v[32:33], v[32:33], v[26:27], v[26:27]
    v_pk_fma_f32 v[34:35], v[34:35], v[26:27], v[26:27]
    v_pk_fma_f32 v[36:37], v[36:37], v[26:27], v[26:27]
    v_pk_fma_f32 v[38:39], v[38:39], v[26:27], v[26:27]
    v_rcp_f32 v32, v32
    v_rcp_f32 v33, v33
    v_rcp_f32 v34, v34
    v_rcp_f32 v35, v35
    v_rcp_f32 v36, v36
    v_rcp_f32 v37, v37
    v_rcp_f32 v38, v38
    v_rcp_f32 v39, v39
    v_pk_mul_f32 v[32:33], v[32:33], v[96:97]
    v_pk_mul_f32 v[34:35], v[34:35], v[98:99]
    v_pk_mul_f32 v[36:37], v[36:37], v[100:101]
    v_pk_mul_f32 v[38:39], v[38:39], v[102:103]
    v_cvt_pk_bf16_f32 v96, v32, v33
    v_cvt_pk_bf16_f32 v97, v34, v35
    v_cvt_pk_bf16_f32 v98, v36, v37
    v_cvt_pk_bf16_f32 v99, v38, v39
    v_pk_mul_f32 v[40:41], v[104:105], v[104:105]
    v_pk_mul_f32 v[42:43], v[106:107], v[106:107]
    v_pk_mul_f32 v[44:45], v[108:109], v[108:109]
    v_pk_mul_f32 v[46:47], v[110:111], v[110:111]
    v_pk_fma_f32 v[40:41], v[40:41], v[30:31], v[28:29]
    v_pk_fma_f32 v[42:43], v[42:43], v[30:31], v[28:29]
    v_pk_fma_f32 v[44:45], v[44:45], v[30:31], v[28:29]
    v_pk_fma_f32 v[46:47], v[46:47], v[30:31], v[28:29]
    v_pk_mul_f32 v[40:41], v[40:41], v[104:105]
    v_pk_mul_f32 v[42:43], v[42:43], v[106:107]
    v_pk_mul_f32 v[44:45], v[44:45], v[108:109]
    v_pk_mul_f32 v[46:47], v[46:47], v[110:111]
    v_exp_f32 v40, v40
    v_exp_f32 v41, v41
    v_exp_f32 v42, v42
    v_exp_f32 v43, v43
    v_exp_f32 v44, v44
    v_exp_f32 v45, v45
    v_exp_f32 v46, v46
    v_exp_f32 v47, v47
    v_pk_fma_f32 v[40:41], v[40:41], v[26:27], v[26:27]
    v_pk_fma_f32 v[42:43], v[42:43], v[26:27], v[26:27]
    v_pk_fma_f32 v[44:45], v[44:45], v[26:27], v[26:27]
    v_pk_fma_f32 v[46:47], v[46:47], v[26:27], v[26:27]
    v_rcp_f32 v40, v40
    v_rcp_f32 v41, v41
    v_rcp_f32 v42, v42
    v_rcp_f32 v43, v43
    v_rcp_f32 v44, v44
    v_rcp_f32 v45, v45
    v_rcp_f32 v46, v46
    v_rcp_f32 v47, v47
    v_pk_mul_f32 v[40:41], v[40:41], v[104:105]
    v_pk_mul_f32 v[42:43], v[42:43], v[106:107]
    v_pk_mul_f32 v[44:45], v[44:45], v[108:109]
    v_pk_mul_f32 v[46:47], v[46:47], v[110:111]
    v_cvt_pk_bf16_f32 v104, v40, v41
    v_cvt_pk_bf16_f32 v105, v42, v43
    v_cvt_pk_bf16_f32 v106, v44, v45
    v_cvt_pk_bf16_f32 v107, v46, v47
    v_pk_mul_f32 v[32:33], v[112:113], v[112:113]
    v_pk_mul_f32 v[34:35], v[114:115], v[114:115]
    v_pk_mul_f32 v[36:37], v[116:117], v[116:117]
    v_pk_mul_f32 v[38:39], v[118:119], v[118:119]
    v_pk_fma_f32 v[32:33], v[32:33], v[30:31], v[28:29]
    v_pk_fma_f32 v[34:35], v[34:35], v[30:31], v[28:29]
    v_pk_fma_f32 v[36:37], v[36:37], v[30:31], v[28:29]
    v_pk_fma_f32 v[38:39], v[38:39], v[30:31], v[28:29]
    v_pk_mul_f32 v[32:33], v[32:33], v[112:113]
    v_pk_mul_f32 v[34:35], v[34:35], v[114:115]
    v_pk_mul_f32 v[36:37], v[36:37], v[116:117]
    v_pk_mul_f32 v[38:39], v[38:39], v[118:119]
    v_exp_f32 v32, v32
    v_exp_f32 v33, v33
    v_exp_f32 v34, v34
    v_exp_f32 v35, v35
    v_exp_f32 v36, v36
    v_exp_f32 v37, v37
    v_exp_f32 v38, v38
    v_exp_f32 v39, v39
    v_pk_fma_f32 v[32:33], v[32:33], v[26:27], v[26:27]
    v_pk_fma_f32 v[34:35], v[34:35], v[26:27], v[26:27]
    v_pk_fma_f32 v[36:37], v[36:37], v[26:27], v[26:27]
    v_pk_fma_f32 v[38:39], v[38:39], v[26:27], v[26:27]
    v_rcp_f32 v32, v32
    v_rcp_f32 v33, v33
    v_rcp_f32 v34, v34
    v_rcp_f32 v35, v35
    v_rcp_f32 v36, v36
    v_rcp_f32 v37, v37
    v_rcp_f32 v38, v38
    v_rcp_f32 v39, v39
    v_pk_mul_f32 v[32:33], v[32:33], v[112:113]
    v_pk_mul_f32 v[34:35], v[34:35], v[114:115]
    v_pk_mul_f32 v[36:37], v[36:37], v[116:117]
    v_pk_mul_f32 v[38:39], v[38:39], v[118:119]
    v_cvt_pk_bf16_f32 v112, v32, v33
    v_cvt_pk_bf16_f32 v113, v34, v35
    v_cvt_pk_bf16_f32 v114, v36, v37
    v_cvt_pk_bf16_f32 v115, v38, v39
    ds_read_b64 v[12:13], v3 offset:48
    s_waitcnt lgkmcnt(0)
    v_readfirstlane_b32 s10, v12
    v_readfirstlane_b32 s11, v13
Lw_7:
    ds_read_b32 v12, v3 offset:12
    s_waitcnt lgkmcnt(0)
    v_cmp_gt_u32 vcc, 4, v12
    s_cbranch_vccz Lwd_8
    s_sleep 0
    s_sub_u32 s3, s3, 1
    s_cbranch_scc0 Lw_7
    s_mov_b32 s3, 0
Lwd_8:
    v_lshrrev_b32 v16, 1, v1
    s_lshl_b32 s56, s52, 4
    s_add_u32 s56, s56, 20
    v_add_u32 v16, s56, v16
    v_min_u32 v16, 63, v16
    v_and_b32 v17, 1, v1
    v_mov_b32 v18, 0x3f803f80
    v_cmp_eq_u32 vcc, 0, v17
    v_mul_u32_u24 v16, 2080, v16
    v_lshl_add_u32 v16, v17, 4, v16
    v_cndmask_b32 v48, 0, v18, vcc
    v_cndmask_b32 v49, 0, v18, vcc
    v_cndmask_b32 v50, 0, v18, vcc
    v_cndmask_b32 v51, 0, v18, vcc
    s_mov_b32 exec_hi, 0
    ds_write_b128 v16, v[48:51] offset:2304
    s_mov_b64 exec, -1
    s_lshl_b32 s82, s68, 17
    s_lshl_b32 s57, s52, 11
    s_add_u32 s82, s82, s57
    s_add_u32 s82, s82, 0x20a000
    s_mul_i32 s83, s52, 2080
Lw_9:
    ds_read_b32 v12, v3 offset:60
    s_waitcnt lgkmcnt(0)
    v_cmp_gt_u32 vcc, 4, v12
    s_cbranch_vccz Lwd_10
    s_sleep 2
    s_sub_u32 s3, s3, 1
    s_cbranch_scc0 Lw_9
    s_mov_b32 s3, 0
Lwd_10:
    s_mov_b32 s59, 0x1400000
Lp_11:
    buffer_load_dwordx2 v[12:13], v24, s[40:43], s59 offen sc1
    s_waitcnt vmcnt(0)
    v_cmp_ne_u64 vcc, s[10:11], v[12:13]
    s_cbranch_vccz Lpd_12
    s_sleep 1
    s_sub_u32 s3, s3, 1
    s_cbranch_scc0 Lp_11
    s_mov_b32 s3, 0
Lpd_12:
    s_add_u32 m0, s83, 41856
    s_nop 0
    buffer_load_dwordx4 v2, s[40:43], s82 offen sc1 lds
    buffer_load_dwordx4 v2, s[40:43], s82 offen offset:1024 sc1 lds
    s_add_u32 s82, s82, 8192
    s_add_u32 m0, s83, 50176
    s_nop 0
    buffer_load_dwordx4 v2, s[40:43], s82 offen sc1 lds
    buffer_load_dwordx4 v2, s[40:43], s82 offen offset:1024 sc1 lds
    s_add_u32 s82, s82, 8192
    s_add_u32 m0, s83, 58496
    s_nop 0
    buffer_load_dwordx4 v2, s[40:43], s82 offen sc1 lds
    buffer_load_dwordx4 v2, s[40:43], s82 offen offset:1024 sc1 lds
    s_add_u32 s82, s82, 8192
    s_add_u32 m0, s83, 66816
    s_nop 0
    buffer_load_dwordx4 v2, s[40:43], s82 offen sc1 lds
    buffer_load_dwordx4 v2, s[40:43], s82 offen offset:1024 sc1 lds
    s_add_u32 s82, s82, 8192
    s_add_u32 m0, s83, 75136
    s_nop 0
    buffer_load_dwordx4 v2, s[40:43], s82 offen sc1 lds
    buffer_load_dwordx4 v2, s[40:43], s82 offen offset:1024 sc1 lds
    s_add_u32 s82, s82, 8192
    s_add_u32 m0, s83, 83456
    s_nop 0
    buffer_load_dwordx4 v2, s[40:43], s82 offen sc1 lds
    buffer_load_dwordx4 v2, s[40:43], s82 offen offset:1024 sc1 lds
    s_add_u32 s82, s82, 8192
    s_add_u32 m0, s83, 91776
    s_nop 0
    buffer_load_dwordx4 v2, s[40:43], s82 offen sc1 lds
    buffer_load_dwordx4 v2, s[40:43], s82 offen offset:1024 sc1 lds
    s_add_u32 s82, s82, 8192
    s_add_u32 m0, s83, 100096
    s_nop 0
    buffer_load_dwordx4 v2, s[40:43], s82 offen sc1 lds
    buffer_load_dwordx4 v2, s[40:43], s82 offen offset:1024 sc1 lds
    s_add_u32 s82, s82, 8192
    s_add_u32 m0, s83, 108416
    s_nop 0
    buffer_load_dwordx4 v2, s[40:43], s82 offen sc1 lds
    buffer_load_dwordx4 v2, s[40:43], s82 offen offset:1024 sc1 lds
    s_add_u32 s82, s82, 8192
    s_add_u32 m0, s83, 116736
    s_nop 0
    buffer_load_dwordx4 v2, s[40:43], s82 offen sc1 lds
    buffer_load_dwordx4 v2, s[40:43], s82 offen offset:1024 sc1 lds
    s_add_u32 s82, s82, 8192
    s_add_u32 m0, s83, 125056
    s_nop 0
    buffer_load_dwordx4 v2, s[40:43], s82 offen sc1 lds
    buffer_load_dwordx4 v2, s[40:43], s82 offen offset:1024 sc1 lds
    s_add_u32 s82, s82, 8192
    s_waitcnt vmcnt(0)
    s_mov_b64 exec, 1
    ds_add_u32 v3, v4 offset:20
    s_mov_b64 exec, -1
Lw_13:
    ds_read_b32 v12, v3 offset:20
    s_waitcnt lgkmcnt(0)
    v_cmp_gt_u32 vcc, 4, v12
    s_cbranch_vccz Lwd_14
    s_sleep 1
    s_sub_u32 s3, s3, 1
    s_cbranch_scc0 Lw_13
    s_mov_b32 s3, 0
Lwd_14:
    s_cmp_lg_u32 s53, 0
    s_cbranch_scc1 B_nog
    v_lshlrev_b32 v12, 2, v1
    s_lshl_b32 s58, s55, 7
    s_add_u32 s58, s58, 0x1300000
    s_mov_b32 exec_hi, 0
    buffer_store_dword v25, v12, s[40:43], s58 offen sc1
    s_mov_b64 exec, -1
B_nog:
    buffer_store_dwordx4 v[64:67], v2, s[40:43], s80 offen offset:0 sc1
    buffer_store_dwordx4 v[72:75], v2, s[40:43], s80 offen offset:1024 sc1
    buffer_store_dwordx4 v[80:83], v2, s[40:43], s80 offen offset:2048 sc1
    buffer_store_dwordx4 v[88:91], v2, s[40:43], s80 offen offset:3072 sc1
    buffer_store_dwordx4 v[96:99], v2, s[40:43], s81 offen offset:0 sc1
    buffer_store_dwordx4 v[104:107], v2, s[40:43], s81 offen offset:1024 sc1
    buffer_store_dwordx4 v[112:115], v2, s[40:43], s81 offen offset:2048 sc1
    s_mov_b32 s44, s16
    s_mov_b32 s45, s17
    s_mov_b32 s46, 0x1c0000
    s_mov_b32 s47, 0x00020000
    s_mov_b32 s48, s8
    s_mov_b32 s49, s9
    s_mov_b32 s50, 0x80000
    s_mov_b32 s51, 0x00020000
    s_lshl_b32 s58, s68, 5
    s_add_u32 s58, s58, 1024
    s_lshl_b32 s57, s52, 2
    s_add_u32 s57, s57, s58
    v_and_b32 v12, 3, v1
    v_bfe_u32 v13, v1, 2, 1
    v_lshl_add_u32 v12, v13, 4, v12
    v_add_u32 v12, s57, v12
    v_and_b32 v13, 1, v1
    v_lshl_add_u32 v13, v13, 4, s58
    v_cmp_gt_u32 vcc, 8, v1
    v_lshrrev_b32 v14, 2, v1
    v_and_b32 v15, 3, v1
    v_cndmask_b32 v12, v13, v12, vcc
    v_lshlrev_b32 v16, 8, v12
    v_lshlrev_b32 v15, 4, v15
    v_lshl_add_u32 v20, v14, 10, v15
    s_mul_i32 s84, s52, 6144
    s_add_u32 s84, s84, 139264
    v_lshrrev_b32 v21, 5, v1
    v_lshlrev_b32 v21, 8, v21
    v_sub_u32 v21, v9, v21
    v_add_u32 v21, s84, v21
    s_and_b32 s77, s68, 3
    s_mul_i32 s77, s77, 7
    s_mul_i32 s56, s69, 3
    s_add_u32 s77, s77, s56
    s_sub_u32 s56, s77, 28
    s_cmp_ge_u32 s77, 28
    s_cselect_b32 s77, s56, s77
    s_mov_b32 s72, s77
    s_mul_i32 s80, s52, 458752
    s_lshl_b32 s56, s69, 7
    s_add_u32 s80, s80, s56
    s_mul_i32 s81, s68, 229376
    s_mul_i32 s56, s52, 28672
    s_add_u32 s81, s81, s56
    s_add_u32 s81, s81, 0x600000
    s_lshl_b32 s83, s55, 4
    s_add_u32 s83, s83, s53
    s_add_u32 s83, s83, 1024
    s_lshl_b32 s82, s69, 7
    s_and_b32 s56, s52, 1
    s_lshl_b32 s56, s56, 6
    s_add_u32 s82, s82, s56
    s_add_u32 s58, s82, 131072
    s_add_u32 m0, s84, 2048
    s_nop 0
    buffer_load_dwordx4 v20, s[48:51], s58 offen lds
    s_add_u32 s58, s58, 16384
    s_add_u32 m0, s84, 3072
    s_nop 0
    buffer_load_dwordx4 v20, s[48:51], s58 offen lds
    s_add_u32 s58, s58, 16384
    s_add_u32 m0, s84, 4096
    s_nop 0
    buffer_load_dwordx4 v20, s[48:51], s58 offen lds
    s_add_u32 s58, s58, 16384
    s_add_u32 m0, s84, 5120
    s_nop 0
    buffer_load_dwordx4 v20, s[48:51], s58 offen lds
    s_add_u32 s58, s58, 16384
    s_add_u32 m0, s84, 0
    s_nop 0
    buffer_load_dwordx4 v20, s[48:51], s58 offen lds
    s_add_u32 s58, s58, 16384
    s_add_u32 m0, s84, 1024
    s_nop 0
    buffer_load_dwordx4 v20, s[48:51], s58 offen lds
    s_add_u32 s58, s58, 16384
    s_waitcnt vmcnt(6)
    v_mov_b32 v14, s10
    v_mov_b32 v15, s11
    s_lshl_b32 s83, s83, 8
    s_add_u32 s83, s83, 0x1400000
    s_mov_b64 exec, 1
    buffer_store_dwordx2 v[14:15], v3, s[40:43], s83 offen sc1
    s_mov_b64 exec, -1
    s_waitcnt vmcnt(6)
    ds_read_b64_tr_b16 a[32:33], v21 offset:2048
    ds_read_b64_tr_b16 a[34:35], v21 offset:2560
    s_waitcnt vmcnt(5)
    ds_read_b64_tr_b16 a[36:37], v21 offset:3072
    ds_read_b64_tr_b16 a[38:39], v21 offset:3584
    s_waitcnt lgkmcnt(2)
    s_add_u32 m0, s84, 2048
    s_nop 0
    buffer_load_dwordx4 v20, s[48:51], s58 offen lds
    s_add_u32 s58, s58, 16384
    s_waitcnt vmcnt(5)
    ds_read_b64_tr_b16 a[40:41], v21 offset:4096
    ds_read_b64_tr_b16 a[42:43], v21 offset:4608
    s_waitcnt lgkmcnt(2)
    s_add_u32 m0, s84, 3072
    s_nop 0
    buffer_load_dwordx4 v20, s[48:51], s58 offen lds
    s_add_u32 s58, s58, 16384
    s_waitcnt vmcnt(5)
    ds_read_b64_tr_b16 a[44:45], v21 offset:5120
    ds_read_b64_tr_b16 a[46:47], v21 offset:5632
    s_waitcnt lgkmcnt(2)
    s_add_u32 m0, s84, 4096
    s_nop 0
    buffer_load_dwordx4 v20, s[48:51], s58 offen lds
    s_add_u32 s58, s58, 16384
    s_waitcnt vmcnt(5)
    ds_read_b64_tr_b16 a[48:49], v21 offset:0
    ds_read_b64_tr_b16 a[50:51], v21 offset:512
    s_waitcnt lgkmcnt(2)
    s_add_u32 m0, s84, 5120
    s_nop 0
    buffer_load_dwordx4 v20, s[48:51], s58 offen lds
    s_add_u32 s58, s58, 16384
    s_waitcnt vmcnt(5)
    ds_read_b64_tr_b16 a[52:53], v21 offset:1024
    ds_read_b64_tr_b16 a[54:55], v21 offset:1536
    s_waitcnt lgkmcnt(2)
    s_add_u32 m0, s84, 0
    s_nop 0
    buffer_load_dwordx4 v20, s[48:51], s58 offen lds
    s_add_u32 s58, s58, 16384
    s_waitcnt vmcnt(4)
    ds_read_b64_tr_b16 a[56:57], v21 offset:2048
    ds_read_b64_tr_b16 a[58:59], v21 offset:2560
    s_waitcnt lgkmcnt(2)
    s_add_u32 m0, s84, 1024
    s_nop 0
    buffer_load_dwordx4 v20, s[48:51], s58 offen lds
    s_add_u32 s58, s58, 16384
    s_waitcnt vmcnt(4)
    ds_read_b64_tr_b16 a[60:61], v21 offset:3072
    ds_read_b64_tr_b16 a[62:63], v21 offset:3584
    s_waitcnt lgkmcnt(2)
    s_add_u32 m0, s84, 2048
    s_nop 0
    buffer_load_dwordx4 v20, s[48:51], s58 offen lds
    s_add_u32 s58, s58, 16384
    s_waitcnt vmcnt(4)
    ds_read_b64_tr_b16 a[64:65], v21 offset:4096
    ds_read_b64_tr_b16 a[66:67], v21 offset:4608
    s_waitcnt lgkmcnt(2)
    s_add_u32 m0, s84, 3072
    s_nop 0
    buffer_load_dwordx4 v20, s[48:51], s58 offen lds
    s_add_u32 s58, s58, 16384
    s_waitcnt vmcnt(4)
    ds_read_b64_tr_b16 a[68:69], v21 offset:5120
    ds_read_b64_tr_b16 a[70:71], v21 offset:5632
    s_waitcnt lgkmcnt(2)
    s_add_u32 m0, s84, 4096
    s_nop 0
    buffer_load_dwordx4 v20, s[48:51], s58 offen lds
    s_add_u32 s58, s58, 16384
    s_waitcnt vmcnt(4)
    ds_read_b64_tr_b16 a[72:73], v21 offset:0
    ds_read_b64_tr_b16 a[74:75], v21 offset:512
    s_waitcnt lgkmcnt(2)
    s_add_u32 m0, s84, 5120
    s_nop 0
    buffer_load_dwordx4 v20, s[48:51], s58 offen lds
    s_add_u32 s58, s58, 16384
    s_waitcnt vmcnt(4)
    ds_read_b64_tr_b16 a[76:77], v21 offset:1024
    ds_read_b64_tr_b16 a[78:79], v21 offset:1536
    s_waitcnt lgkmcnt(2)
    s_add_u32 m0, s84, 0
    s_nop 0
    buffer_load_dwordx4 v20, s[48:51], s58 offen lds
    s_add_u32 s58, s58, 16384
    s_waitcnt vmcnt(4)
    ds_read_b64_tr_b16 a[80:81], v21 offset:2048
    ds_read_b64_tr_b16 a[82:83], v21 offset:2560
    s_waitcnt lgkmcnt(2)
    s_add_u32 m0, s84, 1024
    s_nop 0
    buffer_load_dwordx4 v20, s[48:51], s58 offen lds
    s_add_u32 s58, s58, 16384
    s_waitcnt vmcnt(4)
    ds_read_b64_tr_b16 a[84:85], v21 offset:3072
    ds_read_b64_tr_b16 a[86:87], v21 offset:3584
    s_waitcnt lgkmcnt(2)
    s_add_u32 m0, s84, 2048
    s_nop 0
    buffer_load_dwordx4 v20, s[48:51], s58 offen lds
    s_add_u32 s58, s58, 16384
    s_waitcnt vmcnt(4)
    ds_read_b64_tr_b16 a[88:89], v21 offset:4096
    ds_read_b64_tr_b16 a[90:91], v21 offset:4608
    s_waitcnt lgkmcnt(2)
    s_add_u32 m0, s84, 3072
    s_nop 0
    buffer_load_dwordx4 v20, s[48:51], s58 offen lds
    s_add_u32 s58, s58, 16384
    s_waitcnt vmcnt(4)
    ds_read_b64_tr_b16 a[92:93], v21 offset:5120
    ds_read_b64_tr_b16 a[94:95], v21 offset:5632
    s_waitcnt lgkmcnt(2)
    s_add_u32 m0, s84, 4096
    s_nop 0
    buffer_load_dwordx4 v20, s[48:51], s58 offen lds
    s_add_u32 s58, s58, 16384
    s_waitcnt vmcnt(4)
    ds_read_b64_tr_b16 a[96:97], v21 offset:0
    ds_read_b64_tr_b16 a[98:99], v21 offset:512
    s_waitcnt lgkmcnt(2)
    s_add_u32 m0, s84, 5120
    s_nop 0
    buffer_load_dwordx4 v20, s[48:51], s58 offen lds
    s_add_u32 s58, s58, 16384
    s_waitcnt vmcnt(4)
    ds_read_b64_tr_b16 a[100:101], v21 offset:1024
    ds_read_b64_tr_b16 a[102:103], v21 offset:1536
    s_waitcnt lgkmcnt(2)
    s_add_u32 m0, s84, 0
    s_nop 0
    buffer_load_dwordx4 v20, s[48:51], s58 offen lds
    s_add_u32 s58, s58, 16384
    s_waitcnt vmcnt(4)
    ds_read_b64_tr_b16 a[104:105], v21 offset:2048
    ds_read_b64_tr_b16 a[106:107], v21 offset:2560
    s_waitcnt lgkmcnt(2)
    s_add_u32 m0, s84, 1024
    s_nop 0
    buffer_load_dwordx4 v20, s[48:51], s58 offen lds
    s_add_u32 s58, s58, 16384
    s_mov_b32 s59, 0x1400000
Lp_15:
    buffer_load_dwordx2 v[18:19], v16, s[40:43], s59 offen sc1
    s_waitcnt vmcnt(0)
    v_cmp_ne_u64 vcc, s[10:11], v[18:19]
    s_cbranch_vccz Lpd_16
    s_sleep 4
    s_sub_u32 s3, s3, 1
    s_cbranch_scc0 Lp_15
    s_mov_b32 s3, 0
Lpd_16:
    s_lshl_b32 s56, s72, 10
    s_add_u32 s56, s56, s81
    s_add_u32 s57, s56, 114688
    buffer_load_dwordx4 a[0:3], v2, s[40:43], s56 offen sc1
    s_add_u32 s72, s72, 1
    buffer_load_dwordx4 a[4:7], v2, s[40:43], s57 offen sc1
    s_cmp_eq_u32 s72, 28
    s_cselect_b32 s72, 0, s72
    s_lshl_b32 s56, s72, 10
    s_add_u32 s56, s56, s81
    s_add_u32 s57, s56, 114688
    buffer_load_dwordx4 a[8:11], v2, s[40:43], s56 offen sc1
    s_add_u32 s72, s72, 1
    buffer_load_dwordx4 a[12:15], v2, s[40:43], s57 offen sc1
    s_cmp_eq_u32 s72, 28
    s_cselect_b32 s72, 0, s72
    s_lshl_b32 s56, s72, 10
    s_add_u32 s56, s56, s81
    s_add_u32 s57, s56, 114688
    buffer_load_dwordx4 a[16:19], v2, s[40:43], s56 offen sc1
    s_add_u32 s72, s72, 1
    buffer_load_dwordx4 a[20:23], v2, s[40:43], s57 offen sc1
    s_cmp_eq_u32 s72, 28
    s_cselect_b32 s72, 0, s72
    s_lshl_b32 s56, s72, 10
    s_add_u32 s56, s56, s81
    s_add_u32 s57, s56, 114688
    buffer_load_dwordx4 a[24:27], v2, s[40:43], s56 offen sc1
    s_add_u32 s72, s72, 1
    buffer_load_dwordx4 a[28:31], v2, s[40:43], s57 offen sc1
    s_cmp_eq_u32 s72, 28
    s_cselect_b32 s72, 0, s72
    ds_read_b64_tr_b16 a[108:109], v21 offset:3072
    ds_read_b64_tr_b16 a[110:111], v21 offset:3584
    ds_read_b64_tr_b16 a[112:113], v21 offset:4096
    ds_read_b64_tr_b16 a[114:115], v21 offset:4608
    ds_read_b64_tr_b16 a[116:117], v21 offset:5120
    ds_read_b64_tr_b16 a[118:119], v21 offset:5632
    ds_read_b64_tr_b16 a[120:121], v21 offset:0
    ds_read_b64_tr_b16 a[122:123], v21 offset:512
    ds_read_b64_tr_b16 a[124:125], v21 offset:1024
    ds_read_b64_tr_b16 a[126:127], v21 offset:1536
    s_waitcnt lgkmcnt(0)
    s_lshl_b32 s56, s77, 14
    s_add_u32 s56, s56, s80
    s_add_u32 m0, s84, 0
    s_add_u32 s57, s56, 64
    buffer_load_dwordx4 v20, s[44:47], s56 offen lds
    s_add_u32 m0, s84, 1024
    s_add_u32 s77, s77, 1
    buffer_load_dwordx4 v20, s[44:47], s57 offen lds
    s_cmp_eq_u32 s77, 28
    s_cselect_b32 s77, 0, s77
    s_lshl_b32 s56, s77, 14
    s_add_u32 s56, s56, s80
    s_add_u32 m0, s84, 2048
    s_add_u32 s57, s56, 64
    buffer_load_dwordx4 v20, s[44:47], s56 offen lds
    s_add_u32 m0, s84, 3072
    s_add_u32 s77, s77, 1
    buffer_load_dwordx4 v20, s[44:47], s57 offen lds
    s_cmp_eq_u32 s77, 28
    s_cselect_b32 s77, 0, s77
    s_lshl_b32 s56, s77, 14
    s_add_u32 s56, s56, s80
    s_add_u32 m0, s84, 4096
    s_add_u32 s57, s56, 64
    buffer_load_dwordx4 v20, s[44:47], s56 offen lds
    s_add_u32 m0, s84, 5120
    s_add_u32 s77, s77, 1
    buffer_load_dwordx4 v20, s[44:47], s57 offen lds
    s_cmp_eq_u32 s77, 28
    s_cselect_b32 s77, 0, s77
    s_mov_b32 s28, s18
    s_mov_b32 s29, s19
    s_mov_b32 s30, 0x400
    s_mov_b32 s31, 0x00020000
    s_mov_b32 s32, s22
    s_mov_b32 s33, s23
    s_mov_b32 s34, 0x200000
    s_mov_b32 s35, 0x00020000
    v_and_b32 v12, 31, v1
    v_lshlrev_b32 v13, 2, v12
    v_lshrrev_b32 v14, 5, v1
    v_lshlrev_b32 v15, 3, v14
    v_lshlrev_b32 v26, 10, v12
    v_lshl_add_u32 v26, v14, 4, v26
    s_lshl_b32 s83, s68, 1
    s_lshr_b32 s56, s52, 1
    s_add_u32 s83, s83, s56
    s_lshl_b32 s57, s83, 7
    s_add_u32 s57, s57, 0x1300000
    buffer_load_dword v25, v13, s[40:43], s57 offen sc1
    buffer_load_dwordx2 v[56:57], v15, s[28:31], s82 offen offset:0
    buffer_load_dwordx2 v[58:59], v15, s[28:31], s82 offen offset:16
    buffer_load_dwordx2 v[60:61], v15, s[28:31], s82 offen offset:32
    buffer_load_dwordx2 v[62:63], v15, s[28:31], s82 offen offset:48
    s_lshl_b32 s56, s68, 5
    s_lshl_b32 s57, s52, 3
    s_add_u32 s56, s56, s57
    s_add_u32 s56, s56, 2048
    v_and_b32 v27, 7, v1
    v_add_u32 v27, s56, v27
    v_lshlrev_b32 v27, 8, v27
    s_lshl_b32 s73, s68, 16
    s_lshl_b32 s57, s52, 13
    s_add_u32 s73, s73, s57
    s_add_u32 s73, s73, 0x1100000
    s_add_u32 s74, s57, 50176
    s_lshl_b32 s56, s83, 15
    s_add_u32 s75, s82, s56
    s_lshr_b32 s56, s52, 1
    s_lshl_b32 s56, s56, 15
    s_add_u32 s56, s56, 50176
    v_add_u32 v28, s56, v2
    s_mov_b32 s79, 0x1400000
    s_setprio 0
    s_waitcnt vmcnt(9)
    ds_read_b64_tr_b16 v[32:33], v21 offset:0
    ds_read_b64_tr_b16 v[34:35], v21 offset:512
    ds_read_b64_tr_b16 v[36:37], v21 offset:1024
    ds_read_b64_tr_b16 v[38:39], v21 offset:1536
    s_waitcnt vmcnt(7)
    ds_read_b64_tr_b16 v[40:41], v21 offset:2048
    ds_read_b64_tr_b16 v[42:43], v21 offset:2560
    ds_read_b64_tr_b16 v[44:45], v21 offset:3072
    ds_read_b64_tr_b16 v[46:47], v21 offset:3584
    s_waitcnt lgkmcnt(4)
    s_lshl_b32 s56, s77, 14
    s_add_u32 s56, s56, s80
    s_add_u32 m0, s84, 0
    s_add_u32 s57, s56, 64
    buffer_load_dwordx4 v20, s[44:47], s56 offen lds
    s_add_u32 m0, s84, 1024
    s_add_u32 s77, s77, 1
    buffer_load_dwordx4 v20, s[44:47], s57 offen lds
    s_cmp_eq_u32 s77, 28
    s_cselect_b32 s77, 0, s77
    v_mfma_f32_32x32x16_bf16 v[64:79], v[32:35], a[0:3], 0
    v_mfma_f32_32x32x16_bf16 v[80:95], v[36:39], a[0:3], 0
    v_mfma_f32_32x32x16_bf16 v[96:111], v[32:35], a[4:7], 0
    v_mfma_f32_32x32x16_bf16 v[112:127], v[36:39], a[4:7], 0
    s_lshl_b32 s56, s72, 10
    s_add_u32 s56, s56, s81
    s_add_u32 s57, s56, 114688
    buffer_load_dwordx4 a[0:3], v2, s[40:43], s56 offen sc1
    s_add_u32 s72, s72, 1
    buffer_load_dwordx4 a[4:7], v2, s[40:43], s57 offen sc1
    s_cmp_eq_u32 s72, 28
    s_cselect_b32 s72, 0, s72
    s_waitcnt vmcnt(9)
    ds_read_b64_tr_b16 v[32:33], v21 offset:4096
    ds_read_b64_tr_b16 v[34:35], v21 offset:4608
    ds_read_b64_tr_b16 v[36:37], v21 offset:5120
    ds_read_b64_tr_b16 v[38:39], v21 offset:5632
    s_waitcnt lgkmcnt(4)
    s_lshl_b32 s56, s77, 14
    s_add_u32 s56, s56, s80
    s_add_u32 m0, s84, 2048
    s_add_u32 s57, s56, 64
    buffer_load_dwordx4 v20, s[44:47], s56 offen lds
    s_add_u32 m0, s84, 3072
    s_add_u32 s77, s77, 1
    buffer_load_dwordx4 v20, s[44:47], s57 offen lds
    s_cmp_eq_u32 s77, 28
    s_cselect_b32 s77, 0, s77
    v_mfma_f32_32x32x16_bf16 v[64:79], v[40:43], a[8:11], v[64:79]
    v_mfma_f32_32x32x16_bf16 v[80:95], v[44:47], a[8:11], v[80:95]
    v_mfma_f32_32x32x16_bf16 v[96:111], v[40:43], a[12:15], v[96:111]
    v_mfma_f32_32x32x16_bf16 v[112:127], v[44:47], a[12:15], v[112:127]
    s_lshl_b32 s56, s72, 10
    s_add_u32 s56, s56, s81
    s_add_u32 s57, s56, 114688
    buffer_load_dwordx4 a[8:11], v2, s[40:43], s56 offen sc1
    s_add_u32 s72, s72, 1
    buffer_load_dwordx4 a[12:15], v2, s[40:43], s57 offen sc1
    s_cmp_eq_u32 s72, 28
    s_cselect_b32 s72, 0, s72
    s_waitcnt vmcnt(6)
    ds_read_b64_tr_b16 v[40:41], v21 offset:0
    ds_read_b64_tr_b16 v[42:43], v21 offset:512
    ds_read_b64_tr_b16 v[44:45], v21 offset:1024
    ds_read_b64_tr_b16 v[46:47], v21 offset:1536
    s_waitcnt lgkmcnt(4)
    s_lshl_b32 s56, s77, 14
    s_add_u32 s56, s56, s80
    s_add_u32 m0, s84, 4096
    s_add_u32 s57, s56, 64
    buffer_load_dwordx4 v20, s[44:47], s56 offen lds
    s_add_u32 m0, s84, 5120
    s_add_u32 s77, s77, 1
    buffer_load_dwordx4 v20, s[44:47], s57 offen lds
    s_cmp_eq_u32 s77, 28
    s_cselect_b32 s77, 0, s77
    v_mfma_f32_32x32x16_bf16 v[64:79], v[32:35], a[16:19], v[64:79]
    v_mfma_f32_32x32x16_bf16 v[80:95], v[36:39], a[16:19], v[80:95]
    v_mfma_f32_32x32x16_bf16 v[96:111], v[32:35], a[20:23], v[96:111]
    v_mfma_f32_32x32x16_bf16 v[112:127], v[36:39], a[20:23], v[112:127]
    s_lshl_b32 s56, s72, 10
    s_add_u32 s56, s56, s81
    s_add_u32 s57, s56, 114688
    buffer_load_dwordx4 a[16:19], v2, s[40:43], s56 offen sc1
    s_add_u32 s72, s72, 1
    buffer_load_dwordx4 a[20:23], v2, s[40:43], s57 offen sc1
    s_cmp_eq_u32 s72, 28
    s_cselect_b32 s72, 0, s72
    s_waitcnt vmcnt(6)
    ds_read_b64_tr_b16 v[32:33], v21 offset:2048
    ds_read_b64_tr_b16 v[34:35], v21 offset:2560
    ds_read_b64_tr_b16 v[36:37], v21 offset:3072
    ds_read_b64_tr_b16 v[38:39], v21 offset:3584
    s_waitcnt lgkmcnt(4)
    s_lshl_b32 s56, s77, 14
    s_add_u32 s56, s56, s80
    s_add_u32 m0, s84, 0
    s_add_u32 s57, s56, 64
    buffer_load_dwordx4 v20, s[44:47], s56 offen lds
    s_add_u32 m0, s84, 1024
    s_add_u32 s77, s77, 1
    buffer_load_dwordx4 v20, s[44:47], s57 offen lds
    s_cmp_eq_u32 s77, 28
    s_cselect_b32 s77, 0, s77
    v_mfma_f32_32x32x16_bf16 v[64:79], v[40:43], a[24:27], v[64:79]
    v_mfma_f32_32x32x16_bf16 v[80:95], v[44:47], a[24:27], v[80:95]
    v_mfma_f32_32x32x16_bf16 v[96:111], v[40:43], a[28:31], v[96:111]
    v_mfma_f32_32x32x16_bf16 v[112:127], v[44:47], a[28:31], v[112:127]
    s_lshl_b32 s56, s72, 10
    s_add_u32 s56, s56, s81
    s_add_u32 s57, s56, 114688
    buffer_load_dwordx4 a[24:27], v2, s[40:43], s56 offen sc1
    s_add_u32 s72, s72, 1
    buffer_load_dwordx4 a[28:31], v2, s[40:43], s57 offen sc1
    s_cmp_eq_u32 s72, 28
    s_cselect_b32 s72, 0, s72
    s_waitcnt vmcnt(6)
    ds_read_b64_tr_b16 v[40:41], v21 offset:4096
    ds_read_b64_tr_b16 v[42:43], v21 offset:4608
    ds_read_b64_tr_b16 v[44:45], v21 offset:5120
    ds_read_b64_tr_b16 v[46:47], v21 offset:5632
    s_waitcnt lgkmcnt(4)
    s_lshl_b32 s56, s77, 14
    s_add_u32 s56, s56, s80
    s_add_u32 m0, s84, 2048
    s_add_u32 s57, s56, 64
    buffer_load_dwordx4 v20, s[44:47], s56 offen lds
    s_add_u32 m0, s84, 3072
    s_add_u32 s77, s77, 1
    buffer_load_dwordx4 v20, s[44:47], s57 offen lds
    s_cmp_eq_u32 s77, 28
    s_cselect_b32 s77, 0, s77
    v_mfma_f32_32x32x16_bf16 v[64:79], v[32:35], a[0:3], v[64:79]
    v_mfma_f32_32x32x16_bf16 v[80:95], v[36:39], a[0:3], v[80:95]
    v_mfma_f32_32x32x16_bf16 v[96:111], v[32:35], a[4:7], v[96:111]
    v_mfma_f32_32x32x16_bf16 v[112:127], v[36:39], a[4:7], v[112:127]
    s_lshl_b32 s56, s72, 10
    s_add_u32 s56, s56, s81
    s_add_u32 s57, s56, 114688
    buffer_load_dwordx4 a[0:3], v2, s[40:43], s56 offen sc1
    s_add_u32 s72, s72, 1
    buffer_load_dwordx4 a[4:7], v2, s[40:43], s57 offen sc1
    s_cmp_eq_u32 s72, 28
    s_cselect_b32 s72, 0, s72
    s_waitcnt vmcnt(6)
    ds_read_b64_tr_b16 v[32:33], v21 offset:0
    ds_read_b64_tr_b16 v[34:35], v21 offset:512
    ds_read_b64_tr_b16 v[36:37], v21 offset:1024
    ds_read_b64_tr_b16 v[38:39], v21 offset:1536
    s_waitcnt lgkmcnt(4)
    s_lshl_b32 s56, s77, 14
    s_add_u32 s56, s56, s80
    s_add_u32 m0, s84, 4096
    s_add_u32 s57, s56, 64
    buffer_load_dwordx4 v20, s[44:47], s56 offen lds
    s_add_u32 m0, s84, 5120
    s_add_u32 s77, s77, 1
    buffer_load_dwordx4 v20, s[44:47], s57 offen lds
    s_cmp_eq_u32 s77, 28
    s_cselect_b32 s77, 0, s77
    v_mfma_f32_32x32x16_bf16 v[64:79], v[40:43], a[8:11], v[64:79]
    v_mfma_f32_32x32x16_bf16 v[80:95], v[44:47], a[8:11], v[80:95]
    v_mfma_f32_32x32x16_bf16 v[96:111], v[40:43], a[12:15], v[96:111]
    v_mfma_f32_32x32x16_bf16 v[112:127], v[44:47], a[12:15], v[112:127]
    s_lshl_b32 s56, s72, 10
    s_add_u32 s56, s56, s81
    s_add_u32 s57, s56, 114688
    buffer_load_dwordx4 a[8:11], v2, s[40:43], s56 offen sc1
    s_add_u32 s72, s72, 1
    buffer_load_dwordx4 a[12:15], v2, s[40:43], s57 offen sc1
    s_cmp_eq_u32 s72, 28
    s_cselect_b32 s72, 0, s72
    s_waitcnt vmcnt(6)
    ds_read_b64_tr_b16 v[40:41], v21 offset:2048
    ds_read_b64_tr_b16 v[42:43], v21 offset:2560
    ds_read_b64_tr_b16 v[44:45], v21 offset:3072
    ds_read_b64_tr_b16 v[46:47], v21 offset:3584
    s_waitcnt lgkmcnt(4)
    s_lshl_b32 s56, s77, 14
    s_add_u32 s56, s56, s80
    s_add_u32 m0, s84, 0
    s_add_u32 s57, s56, 64
    buffer_load_dwordx4 v20, s[44:47], s56 offen lds
    s_add_u32 m0, s84, 1024
    s_add_u32 s77, s77, 1
    buffer_load_dwordx4 v20, s[44:47], s57 offen lds
    s_cmp_eq_u32 s77, 28
    s_cselect_b32 s77, 0, s77
    v_mfma_f32_32x32x16_bf16 v[64:79], v[32:35], a[16:19], v[64:79]
    v_mfma_f32_32x32x16_bf16 v[80:95], v[36:39], a[16:19], v[80:95]
    v_mfma_f32_32x32x16_bf16 v[96:111], v[32:35], a[20:23], v[96:111]
    v_mfma_f32_32x32x16_bf16 v[112:127], v[36:39], a[20:23], v[112:127]
    s_lshl_b32 s56, s72, 10
    s_add_u32 s56, s56, s81
    s_add_u32 s57, s56, 114688
    buffer_load_dwordx4 a[16:19], v2, s[40:43], s56 offen sc1
    s_add_u32 s72, s72, 1
    buffer_load_dwordx4 a[20:23], v2, s[40:43], s57 offen sc1
    s_cmp_eq_u32 s72, 28
    s_cselect_b32 s72, 0, s72
    s_waitcnt vmcnt(6)
    ds_read_b64_tr_b16 v[32:33], v21 offset:4096
    ds_read_b64_tr_b16 v[34:35], v21 offset:4608
    ds_read_b64_tr_b16 v[36:37], v21 offset:5120
    ds_read_b64_tr_b16 v[38:39], v21 offset:5632
    s_waitcnt lgkmcnt(4)
    s_lshl_b32 s56, s77, 14
    s_add_u32 s56, s56, s80
    s_add_u32 m0, s84, 2048
    s_add_u32 s57, s56, 64
    buffer_load_dwordx4 v20, s[44:47], s56 offen lds
    s_add_u32 m0, s84, 3072
    s_add_u32 s77, s77, 1
    buffer_load_dwordx4 v20, s[44:47], s57 offen lds
    s_cmp_eq_u32 s77, 28
    s_cselect_b32 s77, 0, s77
    v_mfma_f32_32x32x16_bf16 v[64:79], v[40:43], a[24:27], v[64:79]
    v_mfma_f32_32x32x16_bf16 v[80:95], v[44:47], a[24:27], v[80:95]
    v_mfma_f32_32x32x16_bf16 v[96:111], v[40:43], a[28:31], v[96:111]
    v_mfma_f32_32x32x16_bf16 v[112:127], v[44:47], a[28:31], v[112:127]
    s_lshl_b32 s56, s72, 10
    s_add_u32 s56, s56, s81
    s_add_u32 s57, s56, 114688
    buffer_load_dwordx4 a[24:27], v2, s[40:43], s56 offen sc1
    s_add_u32 s72, s72, 1
    buffer_load_dwordx4 a[28:31], v2, s[40:43], s57 offen sc1
    s_cmp_eq_u32 s72, 28
    s_cselect_b32 s72, 0, s72
    s_waitcnt vmcnt(6)
    ds_read_b64_tr_b16 v[40:41], v21 offset:0
    ds_read_b64_tr_b16 v[42:43], v21 offset:512
    ds_read_b64_tr_b16 v[44:45], v21 offset:1024
    ds_read_b64_tr_b16 v[46:47], v21 offset:1536
    s_waitcnt lgkmcnt(4)
    s_lshl_b32 s56, s77, 14
    s_add_u32 s56, s56, s80
    s_add_u32 m0, s84, 4096
    s_add_u32 s57, s56, 64
    buffer_load_dwordx4 v20, s[44:47], s56 offen lds
    s_add_u32 m0, s84, 5120
    s_add_u32 s77, s77, 1
    buffer_load_dwordx4 v20, s[44:47], s57 offen lds
    s_cmp_eq_u32 s77, 28
    s_cselect_b32 s77, 0, s77
    v_mfma_f32_32x32x16_bf16 v[64:79], v[32:35], a[0:3], v[64:79]
    v_mfma_f32_32x32x16_bf16 v[80:95], v[36:39], a[0:3], v[80:95]
    v_mfma_f32_32x32x16_bf16 v[96:111], v[32:35], a[4:7], v[96:111]
    v_mfma_f32_32x32x16_bf16 v[112:127], v[36:39], a[4:7], v[112:127]
    s_lshl_b32 s56, s72, 10
    s_add_u32 s56, s56, s81
    s_add_u32 s57, s56, 114688
    buffer_load_dwordx4 a[0:3], v2, s[40:43], s56 offen sc1
    s_add_u32 s72, s72, 1
    buffer_load_dwordx4 a[4:7], v2, s[40:43], s57 offen sc1
    s_cmp_eq_u32 s72, 28
    s_cselect_b32 s72, 0, s72
    s_waitcnt vmcnt(6)
    ds_read_b64_tr_b16 v[32:33], v21 offset:2048
    ds_read_b64_tr_b16 v[34:35], v21 offset:2560
    ds_read_b64_tr_b16 v[36:37], v21 offset:3072
    ds_read_b64_tr_b16 v[38:39], v21 offset:3584
    s_waitcnt lgkmcnt(4)
    s_lshl_b32 s56, s77, 14
    s_add_u32 s56, s56, s80
    s_add_u32 m0, s84, 0
    s_add_u32 s57, s56, 64
    buffer_load_dwordx4 v20, s[44:47], s56 offen lds
    s_add_u32 m0, s84, 1024
    s_add_u32 s77, s77, 1
    buffer_load_dwordx4 v20, s[44:47], s57 offen lds
    s_cmp_eq_u32 s77, 28
    s_cselect_b32 s77, 0, s77
    v_mfma_f32_32x32x16_bf16 v[64:79], v[40:43], a[8:11], v[64:79]
    v_mfma_f32_32x32x16_bf16 v[80:95], v[44:47], a[8:11], v[80:95]
    v_mfma_f32_32x32x16_bf16 v[96:111], v[40:43], a[12:15], v[96:111]
    v_mfma_f32_32x32x16_bf16 v[112:127], v[44:47], a[12:15], v[112:127]
    s_lshl_b32 s56, s72, 10
    s_add_u32 s56, s56, s81
    s_add_u32 s57, s56, 114688
    buffer_load_dwordx4 a[8:11], v2, s[40:43], s56 offen sc1
    s_add_u32 s72, s72, 1
    buffer_load_dwordx4 a[12:15], v2, s[40:43], s57 offen sc1
    s_cmp_eq_u32 s72, 28
    s_cselect_b32 s72, 0, s72
    s_waitcnt vmcnt(6)
    ds_read_b64_tr_b16 v[40:41], v21 offset:4096
    ds_read_b64_tr_b16 v[42:43], v21 offset:4608
    ds_read_b64_tr_b16 v[44:45], v21 offset:5120
    ds_read_b64_tr_b16 v[46:47], v21 offset:5632
    s_waitcnt lgkmcnt(4)
    s_lshl_b32 s56, s77, 14
    s_add_u32 s56, s56, s80
    s_add_u32 m0, s84, 2048
    s_add_u32 s57, s56, 64
    buffer_load_dwordx4 v20, s[44:47], s56 offen lds
    s_add_u32 m0, s84, 3072
    s_add_u32 s77, s77, 1
    buffer_load_dwordx4 v20, s[44:47], s57 offen lds
    s_cmp_eq_u32 s77, 28
    s_cselect_b32 s77, 0, s77
    v_mfma_f32_32x32x16_bf16 v[64:79], v[32:35], a[16:19], v[64:79]
    v_mfma_f32_32x32x16_bf16 v[80:95], v[36:39], a[16:19], v[80:95]
    v_mfma_f32_32x32x16_bf16 v[96:111], v[32:35], a[20:23], v[96:111]
    v_mfma_f32_32x32x16_bf16 v[112:127], v[36:39], a[20:23], v[112:127]
    s_lshl_b32 s56, s72, 10
    s_add_u32 s56, s56, s81
    s_add_u32 s57, s56, 114688
    buffer_load_dwordx4 a[16:19], v2, s[40:43], s56 offen sc1
    s_add_u32 s72, s72, 1
    buffer_load_dwordx4 a[20:23], v2, s[40:43], s57 offen sc1
    s_cmp_eq_u32 s72, 28
    s_cselect_b32 s72, 0, s72
    s_waitcnt vmcnt(6)
    ds_read_b64_tr_b16 v[32:33], v21 offset:0
    ds_read_b64_tr_b16 v[34:35], v21 offset:512
    ds_read_b64_tr_b16 v[36:37], v21 offset:1024
    ds_read_b64_tr_b16 v[38:39], v21 offset:1536
    s_waitcnt lgkmcnt(4)
    s_lshl_b32 s56, s77, 14
    s_add_u32 s56, s56, s80
    s_add_u32 m0, s84, 4096
    s_add_u32 s57, s56, 64
    buffer_load_dwordx4 v20, s[44:47], s56 offen lds
    s_add_u32 m0, s84, 5120
    s_add_u32 s77, s77, 1
    buffer_load_dwordx4 v20, s[44:47], s57 offen lds
    s_cmp_eq_u32 s77, 28
    s_cselect_b32 s77, 0, s77
    v_mfma_f32_32x32x16_bf16 v[64:79], v[40:43], a[24:27], v[64:79]
    v_mfma_f32_32x32x16_bf16 v[80:95], v[44:47], a[24:27], v[80:95]
    v_mfma_f32_32x32x16_bf16 v[96:111], v[40:43], a[28:31], v[96:111]
    v_mfma_f32_32x32x16_bf16 v[112:127], v[44:47], a[28:31], v[112:127]
    s_lshl_b32 s56, s72, 10
    s_add_u32 s56, s56, s81
    s_add_u32 s57, s56, 114688
    buffer_load_dwordx4 a[24:27], v2, s[40:43], s56 offen sc1
    s_add_u32 s72, s72, 1
    buffer_load_dwordx4 a[28:31], v2, s[40:43], s57 offen sc1
    s_cmp_eq_u32 s72, 28
    s_cselect_b32 s72, 0, s72
    s_waitcnt vmcnt(6)
    ds_read_b64_tr_b16 v[40:41], v21 offset:2048
    ds_read_b64_tr_b16 v[42:43], v21 offset:2560
    ds_read_b64_tr_b16 v[44:45], v21 offset:3072
    ds_read_b64_tr_b16 v[46:47], v21 offset:3584
    s_waitcnt lgkmcnt(4)
    s_lshl_b32 s56, s77, 14
    s_add_u32 s56, s56, s80
    s_add_u32 m0, s84, 0
    s_add_u32 s57, s56, 64
    buffer_load_dwordx4 v20, s[44:47], s56 offen lds
    s_add_u32 m0, s84, 1024
    s_add_u32 s77, s77, 1
    buffer_load_dwordx4 v20, s[44:47], s57 offen lds
    s_cmp_eq_u32 s77, 28
    s_cselect_b32 s77, 0, s77
    v_mfma_f32_32x32x16_bf16 v[64:79], v[32:35], a[0:3], v[64:79]
    v_mfma_f32_32x32x16_bf16 v[80:95], v[36:39], a[0:3], v[80:95]
    v_mfma_f32_32x32x16_bf16 v[96:111], v[32:35], a[4:7], v[96:111]
    v_mfma_f32_32x32x16_bf16 v[112:127], v[36:39], a[4:7], v[112:127]
    s_lshl_b32 s56, s72, 10
    s_add_u32 s56, s56, s81
    s_add_u32 s57, s56, 114688
    buffer_load_dwordx4 a[0:3], v2, s[40:43], s56 offen sc1
    s_add_u32 s72, s72, 1
    buffer_load_dwordx4 a[4:7], v2, s[40:43], s57 offen sc1
    s_cmp_eq_u32 s72, 28
    s_cselect_b32 s72, 0, s72
    s_waitcnt vmcnt(6)
    ds_read_b64_tr_b16 v[32:33], v21 offset:4096
    ds_read_b64_tr_b16 v[34:35], v21 offset:4608
    ds_read_b64_tr_b16 v[36:37], v21 offset:5120
    ds_read_b64_tr_b16 v[38:39], v21 offset:5632
    s_waitcnt lgkmcnt(4)
    s_lshl_b32 s56, s77, 14
    s_add_u32 s56, s56, s80
    s_add_u32 m0, s84, 2048
    s_add_u32 s57, s56, 64
    buffer_load_dwordx4 v20, s[44:47], s56 offen lds
    s_add_u32 m0, s84, 3072
    s_add_u32 s77, s77, 1
    buffer_load_dwordx4 v20, s[44:47], s57 offen lds
    s_cmp_eq_u32 s77, 28
    s_cselect_b32 s77, 0, s77
    v_mfma_f32_32x32x16_bf16 v[64:79], v[40:43], a[8:11], v[64:79]
    v_mfma_f32_32x32x16_bf16 v[80:95], v[44:47], a[8:11], v[80:95]
    v_mfma_f32_32x32x16_bf16 v[96:111], v[40:43], a[12:15], v[96:111]
    v_mfma_f32_32x32x16_bf16 v[112:127], v[44:47], a[12:15], v[112:127]
    s_lshl_b32 s56, s72, 10
    s_add_u32 s56, s56, s81
    s_add_u32 s57, s56, 114688
    buffer_load_dwordx4 a[8:11], v2, s[40:43], s56 offen sc1
    s_add_u32 s72, s72, 1
    buffer_load_dwordx4 a[12:15], v2, s[40:43], s57 offen sc1
    s_cmp_eq_u32 s72, 28
    s_cselect_b32 s72, 0, s72
    s_waitcnt vmcnt(6)
    ds_read_b64_tr_b16 v[40:41], v21 offset:0
    ds_read_b64_tr_b16 v[42:43], v21 offset:512
    ds_read_b64_tr_b16 v[44:45], v21 offset:1024
    ds_read_b64_tr_b16 v[46:47], v21 offset:1536
    s_waitcnt lgkmcnt(4)
    s_lshl_b32 s56, s77, 14
    s_add_u32 s56, s56, s80
    s_add_u32 m0, s84, 4096
    s_add_u32 s57, s56, 64
    buffer_load_dwordx4 v20, s[44:47], s56 offen lds
    s_add_u32 m0, s84, 5120
    s_add_u32 s77, s77, 1
    buffer_load_dwordx4 v20, s[44:47], s57 offen lds
    s_cmp_eq_u32 s77, 28
    s_cselect_b32 s77, 0, s77
    v_mfma_f32_32x32x16_bf16 v[64:79], v[32:35], a[16:19], v[64:79]
    v_mfma_f32_32x32x16_bf16 v[80:95], v[36:39], a[16:19], v[80:95]
    v_mfma_f32_32x32x16_bf16 v[96:111], v[32:35], a[20:23], v[96:111]
    v_mfma_f32_32x32x16_bf16 v[112:127], v[36:39], a[20:23], v[112:127]
    s_lshl_b32 s56, s72, 10
    s_add_u32 s56, s56, s81
    s_add_u32 s57, s56, 114688
    buffer_load_dwordx4 a[16:19], v2, s[40:43], s56 offen sc1
    s_add_u32 s72, s72, 1
    buffer_load_dwordx4 a[20:23], v2, s[40:43], s57 offen sc1
    s_cmp_eq_u32 s72, 28
    s_cselect_b32 s72, 0, s72
    s_waitcnt vmcnt(6)
    ds_read_b64_tr_b16 v[32:33], v21 offset:2048
    ds_read_b64_tr_b16 v[34:35], v21 offset:2560
    ds_read_b64_tr_b16 v[36:37], v21 offset:3072
    ds_read_b64_tr_b16 v[38:39], v21 offset:3584
    s_waitcnt lgkmcnt(4)
    s_lshl_b32 s56, s77, 14
    s_add_u32 s56, s56, s80
    s_add_u32 m0, s84, 0
    s_add_u32 s57, s56, 64
    buffer_load_dwordx4 v20, s[44:47], s56 offen lds
    s_add_u32 m0, s84, 1024
    s_add_u32 s77, s77, 1
    buffer_load_dwordx4 v20, s[44:47], s57 offen lds
    s_cmp_eq_u32 s77, 28
    s_cselect_b32 s77, 0, s77
    v_mfma_f32_32x32x16_bf16 v[64:79], v[40:43], a[24:27], v[64:79]
    v_mfma_f32_32x32x16_bf16 v[80:95], v[44:47], a[24:27], v[80:95]
    v_mfma_f32_32x32x16_bf16 v[96:111], v[40:43], a[28:31], v[96:111]
    v_mfma_f32_32x32x16_bf16 v[112:127], v[44:47], a[28:31], v[112:127]
    s_lshl_b32 s56, s72, 10
    s_add_u32 s56, s56, s81
    s_add_u32 s57, s56, 114688
    buffer_load_dwordx4 a[24:27], v2, s[40:43], s56 offen sc1
    s_add_u32 s72, s72, 1
    buffer_load_dwordx4 a[28:31], v2, s[40:43], s57 offen sc1
    s_cmp_eq_u32 s72, 28
    s_cselect_b32 s72, 0, s72
    s_waitcnt vmcnt(6)
    ds_read_b64_tr_b16 v[40:41], v21 offset:4096
    ds_read_b64_tr_b16 v[42:43], v21 offset:4608
    ds_read_b64_tr_b16 v[44:45], v21 offset:5120
    ds_read_b64_tr_b16 v[46:47], v21 offset:5632
    s_waitcnt lgkmcnt(4)
    s_lshl_b32 s56, s77, 14
    s_add_u32 s56, s56, s80
    s_add_u32 m0, s84, 2048
    s_add_u32 s57, s56, 64
    buffer_load_dwordx4 v20, s[44:47], s56 offen lds
    s_add_u32 m0, s84, 3072
    s_add_u32 s77, s77, 1
    buffer_load_dwordx4 v20, s[44:47], s57 offen lds
    s_cmp_eq_u32 s77, 28
    s_cselect_b32 s77, 0, s77
    v_mfma_f32_32x32x16_bf16 v[64:79], v[32:35], a[0:3], v[64:79]
    v_mfma_f32_32x32x16_bf16 v[80:95], v[36:39], a[0:3], v[80:95]
    v_mfma_f32_32x32x16_bf16 v[96:111], v[32:35], a[4:7], v[96:111]
    v_mfma_f32_32x32x16_bf16 v[112:127], v[36:39], a[4:7], v[112:127]
    s_lshl_b32 s56, s72, 10
    s_add_u32 s56, s56, s81
    s_add_u32 s57, s56, 114688
    buffer_load_dwordx4 a[0:3], v2, s[40:43], s56 offen sc1
    s_add_u32 s72, s72, 1
    buffer_load_dwordx4 a[4:7], v2, s[40:43], s57 offen sc1
    s_cmp_eq_u32 s72, 28
    s_cselect_b32 s72, 0, s72
    s_waitcnt vmcnt(6)
    ds_read_b64_tr_b16 v[32:33], v21 offset:0
    ds_read_b64_tr_b16 v[34:35], v21 offset:512
    ds_read_b64_tr_b16 v[36:37], v21 offset:1024
    ds_read_b64_tr_b16 v[38:39], v21 offset:1536
    s_waitcnt lgkmcnt(4)
    s_lshl_b32 s56, s77, 14
    s_add_u32 s56, s56, s80
    s_add_u32 m0, s84, 4096
    s_add_u32 s57, s56, 64
    buffer_load_dwordx4 v20, s[44:47], s56 offen lds
    s_add_u32 m0, s84, 5120
    s_add_u32 s77, s77, 1
    buffer_load_dwordx4 v20, s[44:47], s57 offen lds
    s_cmp_eq_u32 s77, 28
    s_cselect_b32 s77, 0, s77
    v_mfma_f32_32x32x16_bf16 v[64:79], v[40:43], a[8:11], v[64:79]
    v_mfma_f32_32x32x16_bf16 v[80:95], v[44:47], a[8:11], v[80:95]
    v_mfma_f32_32x32x16_bf16 v[96:111], v[40:43], a[12:15], v[96:111]
    v_mfma_f32_32x32x16_bf16 v[112:127], v[44:47], a[12:15], v[112:127]
    s_lshl_b32 s56, s72, 10
    s_add_u32 s56, s56, s81
    s_add_u32 s57, s56, 114688
    buffer_load_dwordx4 a[8:11], v2, s[40:43], s56 offen sc1
    s_add_u32 s72, s72, 1
    buffer_load_dwordx4 a[12:15], v2, s[40:43], s57 offen sc1
    s_cmp_eq_u32 s72, 28
    s_cselect_b32 s72, 0, s72
    s_waitcnt vmcnt(6)
    ds_read_b64_tr_b16 v[40:41], v21 offset:2048
    ds_read_b64_tr_b16 v[42:43], v21 offset:2560
    ds_read_b64_tr_b16 v[44:45], v21 offset:3072
    ds_read_b64_tr_b16 v[46:47], v21 offset:3584
    s_waitcnt lgkmcnt(4)
    s_lshl_b32 s56, s77, 14
    s_add_u32 s56, s56, s80
    s_add_u32 m0, s84, 0
    s_add_u32 s57, s56, 64
    buffer_load_dwordx4 v20, s[44:47], s56 offen lds
    s_add_u32 m0, s84, 1024
    s_add_u32 s77, s77, 1
    buffer_load_dwordx4 v20, s[44:47], s57 offen lds
    s_cmp_eq_u32 s77, 28
    s_cselect_b32 s77, 0, s77
    v_mfma_f32_32x32x16_bf16 v[64:79], v[32:35], a[16:19], v[64:79]
    v_mfma_f32_32x32x16_bf16 v[80:95], v[36:39], a[16:19], v[80:95]
    v_mfma_f32_32x32x16_bf16 v[96:111], v[32:35], a[20:23], v[96:111]
    v_mfma_f32_32x32x16_bf16 v[112:127], v[36:39], a[20:23], v[112:127]
    s_lshl_b32 s56, s72, 10
    s_add_u32 s56, s56, s81
    s_add_u32 s57, s56, 114688
    buffer_load_dwordx4 a[16:19], v2, s[40:43], s56 offen sc1
    s_add_u32 s72, s72, 1
    buffer_load_dwordx4 a[20:23], v2, s[40:43], s57 offen sc1
    s_cmp_eq_u32 s72, 28
    s_cselect_b32 s72, 0, s72
    s_waitcnt vmcnt(6)
    ds_read_b64_tr_b16 v[32:33], v21 offset:4096
    ds_read_b64_tr_b16 v[34:35], v21 offset:4608
    ds_read_b64_tr_b16 v[36:37], v21 offset:5120
    ds_read_b64_tr_b16 v[38:39], v21 offset:5632
    s_waitcnt lgkmcnt(4)
    s_lshl_b32 s56, s77, 14
    s_add_u32 s56, s56, s80
    s_add_u32 m0, s84, 2048
    s_add_u32 s57, s56, 64
    buffer_load_dwordx4 v20, s[44:47], s56 offen lds
    s_add_u32 m0, s84, 3072
    s_add_u32 s77, s77, 1
    buffer_load_dwordx4 v20, s[44:47], s57 offen lds
    s_cmp_eq_u32 s77, 28
    s_cselect_b32 s77, 0, s77
    v_mfma_f32_32x32x16_bf16 v[64:79], v[40:43], a[24:27], v[64:79]
    v_mfma_f32_32x32x16_bf16 v[80:95], v[44:47], a[24:27], v[80:95]
    v_mfma_f32_32x32x16_bf16 v[96:111], v[40:43], a[28:31], v[96:111]
    v_mfma_f32_32x32x16_bf16 v[112:127], v[44:47], a[28:31], v[112:127]
    s_lshl_b32 s56, s72, 10
    s_add_u32 s56, s56, s81
    s_add_u32 s57, s56, 114688
    buffer_load_dwordx4 a[24:27], v2, s[40:43], s56 offen sc1
    s_add_u32 s72, s72, 1
    buffer_load_dwordx4 a[28:31], v2, s[40:43], s57 offen sc1
    s_cmp_eq_u32 s72, 28
    s_cselect_b32 s72, 0, s72
    s_waitcnt vmcnt(6)
    ds_read_b64_tr_b16 v[40:41], v21 offset:0
    ds_read_b64_tr_b16 v[42:43], v21 offset:512
    ds_read_b64_tr_b16 v[44:45], v21 offset:1024
    ds_read_b64_tr_b16 v[46:47], v21 offset:1536
    s_waitcnt lgkmcnt(4)
    s_lshl_b32 s56, s77, 14
    s_add_u32 s56, s56, s80
    s_add_u32 m0, s84, 4096
    s_add_u32 s57, s56, 64
    buffer_load_dwordx4 v20, s[44:47], s56 offen lds
    s_add_u32 m0, s84, 5120
    s_add_u32 s77, s77, 1
    buffer_load_dwordx4 v20, s[44:47], s57 offen lds
    s_cmp_eq_u32 s77, 28
    s_cselect_b32 s77, 0, s77
    v_mfma_f32_32x32x16_bf16 v[64:79], v[32:35], a[0:3], v[64:79]
    v_mfma_f32_32x32x16_bf16 v[80:95], v[36:39], a[0:3], v[80:95]
    v_mfma_f32_32x32x16_bf16 v[96:111], v[32:35], a[4:7], v[96:111]
    v_mfma_f32_32x32x16_bf16 v[112:127], v[36:39], a[4:7], v[112:127]
    s_lshl_b32 s56, s72, 10
    s_add_u32 s56, s56, s81
    s_add_u32 s57, s56, 114688
    buffer_load_dwordx4 a[0:3], v2, s[40:43], s56 offen sc1
    s_add_u32 s72, s72, 1
    buffer_load_dwordx4 a[4:7], v2, s[40:43], s57 offen sc1
    s_cmp_eq_u32 s72, 28
    s_cselect_b32 s72, 0, s72
    s_waitcnt vmcnt(6)
    ds_read_b64_tr_b16 v[32:33], v21 offset:2048
    ds_read_b64_tr_b16 v[34:35], v21 offset:2560
    ds_read_b64_tr_b16 v[36:37], v21 offset:3072
    ds_read_b64_tr_b16 v[38:39], v21 offset:3584
    s_waitcnt lgkmcnt(4)
    s_lshl_b32 s56, s77, 14
    s_add_u32 s56, s56, s80
    s_add_u32 m0, s84, 0
    s_add_u32 s57, s56, 64
    buffer_load_dwordx4 v20, s[44:47], s56 offen lds
    s_add_u32 m0, s84, 1024
    s_add_u32 s77, s77, 1
    buffer_load_dwordx4 v20, s[44:47], s57 offen lds
    s_cmp_eq_u32 s77, 28
    s_cselect_b32 s77, 0, s77
    v_mfma_f32_32x32x16_bf16 v[64:79], v[40:43], a[8:11], v[64:79]
    v_mfma_f32_32x32x16_bf16 v[80:95], v[44:47], a[8:11], v[80:95]
    v_mfma_f32_32x32x16_bf16 v[96:111], v[40:43], a[12:15], v[96:111]
    v_mfma_f32_32x32x16_bf16 v[112:127], v[44:47], a[12:15], v[112:127]
    s_lshl_b32 s56, s72, 10
    s_add_u32 s56, s56, s81
    s_add_u32 s57, s56, 114688
    buffer_load_dwordx4 a[8:11], v2, s[40:43], s56 offen sc1
    s_add_u32 s72, s72, 1
    buffer_load_dwordx4 a[12:15], v2, s[40:43], s57 offen sc1
    s_cmp_eq_u32 s72, 28
    s_cselect_b32 s72, 0, s72
    s_waitcnt vmcnt(6)
    ds_read_b64_tr_b16 v[40:41], v21 offset:4096
    ds_read_b64_tr_b16 v[42:43], v21 offset:4608
    ds_read_b64_tr_b16 v[44:45], v21 offset:5120
    ds_read_b64_tr_b16 v[46:47], v21 offset:5632
    s_waitcnt lgkmcnt(4)
    s_lshl_b32 s56, s77, 14
    s_add_u32 s56, s56, s80
    s_add_u32 m0, s84, 2048
    s_add_u32 s57, s56, 64
    buffer_load_dwordx4 v20, s[44:47], s56 offen lds
    s_add_u32 m0, s84, 3072
    s_add_u32 s77, s77, 1
    buffer_load_dwordx4 v20, s[44:47], s57 offen lds
    s_cmp_eq_u32 s77, 28
    s_cselect_b32 s77, 0, s77
    v_mfma_f32_32x32x16_bf16 v[64:79], v[32:35], a[16:19], v[64:79]
    v_mfma_f32_32x32x16_bf16 v[80:95], v[36:39], a[16:19], v[80:95]
    v_mfma_f32_32x32x16_bf16 v[96:111], v[32:35], a[20:23], v[96:111]
    v_mfma_f32_32x32x16_bf16 v[112:127], v[36:39], a[20:23], v[112:127]
    s_lshl_b32 s56, s72, 10
    s_add_u32 s56, s56, s81
    s_add_u32 s57, s56, 114688
    buffer_load_dwordx4 a[16:19], v2, s[40:43], s56 offen sc1
    s_add_u32 s72, s72, 1
    buffer_load_dwordx4 a[20:23], v2, s[40:43], s57 offen sc1
    s_cmp_eq_u32 s72, 28
    s_cselect_b32 s72, 0, s72
    s_waitcnt vmcnt(6)
    ds_read_b64_tr_b16 v[32:33], v21 offset:0
    ds_read_b64_tr_b16 v[34:35], v21 offset:512
    ds_read_b64_tr_b16 v[36:37], v21 offset:1024
    ds_read_b64_tr_b16 v[38:39], v21 offset:1536
    s_waitcnt lgkmcnt(4)
    s_lshl_b32 s56, s77, 14
    s_add_u32 s56, s56, s80
    s_add_u32 m0, s84, 4096
    s_add_u32 s57, s56, 64
    buffer_load_dwordx4 v20, s[44:47], s56 offen lds
    s_add_u32 m0, s84, 5120
    s_add_u32 s77, s77, 1
    buffer_load_dwordx4 v20, s[44:47], s57 offen lds
    s_cmp_eq_u32 s77, 28
    s_cselect_b32 s77, 0, s77
    v_mfma_f32_32x32x16_bf16 v[64:79], v[40:43], a[24:27], v[64:79]
    v_mfma_f32_32x32x16_bf16 v[80:95], v[44:47], a[24:27], v[80:95]
    v_mfma_f32_32x32x16_bf16 v[96:111], v[40:43], a[28:31], v[96:111]
    v_mfma_f32_32x32x16_bf16 v[112:127], v[44:47], a[28:31], v[112:127]
    s_lshl_b32 s56, s72, 10
    s_add_u32 s56, s56, s81
    s_add_u32 s57, s56, 114688
    buffer_load_dwordx4 a[24:27], v2, s[40:43], s56 offen sc1
    s_add_u32 s72, s72, 1
    buffer_load_dwordx4 a[28:31], v2, s[40:43], s57 offen sc1
    s_cmp_eq_u32 s72, 28
    s_cselect_b32 s72, 0, s72
    s_waitcnt vmcnt(6)
    ds_read_b64_tr_b16 v[40:41], v21 offset:2048
    ds_read_b64_tr_b16 v[42:43], v21 offset:2560
    ds_read_b64_tr_b16 v[44:45], v21 offset:3072
    ds_read_b64_tr_b16 v[46:47], v21 offset:3584
    s_waitcnt lgkmcnt(4)
    s_lshl_b32 s56, s77, 14
    s_add_u32 s56, s56, s80
    s_add_u32 m0, s84, 0
    s_add_u32 s57, s56, 64
    buffer_load_dwordx4 v20, s[44:47], s56 offen lds
    s_add_u32 m0, s84, 1024
    s_add_u32 s77, s77, 1
    buffer_load_dwordx4 v20, s[44:47], s57 offen lds
    s_cmp_eq_u32 s77, 28
    s_cselect_b32 s77, 0, s77
    v_mfma_f32_32x32x16_bf16 v[64:79], v[32:35], a[0:3], v[64:79]
    v_mfma_f32_32x32x16_bf16 v[80:95], v[36:39], a[0:3], v[80:95]
    v_mfma_f32_32x32x16_bf16 v[96:111], v[32:35], a[4:7], v[96:111]
    v_mfma_f32_32x32x16_bf16 v[112:127], v[36:39], a[4:7], v[112:127]
    s_waitcnt vmcnt(4)
    ds_read_b64_tr_b16 v[32:33], v21 offset:4096
    ds_read_b64_tr_b16 v[34:35], v21 offset:4608
    ds_read_b64_tr_b16 v[36:37], v21 offset:5120
    ds_read_b64_tr_b16 v[38:39], v21 offset:5632
    s_waitcnt lgkmcnt(4)
    s_mov_b32 s58, s82
    s_add_u32 m0, s84, 2048
    s_nop 0
    buffer_load_dwordx4 v20, s[48:51], s58 offen lds
    s_add_u32 s58, s58, 16384
    s_add_u32 m0, s84, 3072
    s_nop 0
    buffer_load_dwordx4 v20, s[48:51], s58 offen lds
    s_add_u32 s58, s58, 16384
    v_mfma_f32_32x32x16_bf16 v[64:79], v[40:43], a[8:11], v[64:79]
    v_mfma_f32_32x32x16_bf16 v[80:95], v[44:47], a[8:11], v[80:95]
    v_mfma_f32_32x32x16_bf16 v[96:111], v[40:43], a[12:15], v[96:111]
    v_mfma_f32_32x32x16_bf16 v[112:127], v[44:47], a[12:15], v[112:127]
    s_waitcnt vmcnt(2)
    ds_read_b64_tr_b16 v[40:41], v21 offset:0
    ds_read_b64_tr_b16 v[42:43], v21 offset:512
    ds_read_b64_tr_b16 v[44:45], v21 offset:1024
    ds_read_b64_tr_b16 v[46:47], v21 offset:1536
    s_waitcnt lgkmcnt(4)
    s_add_u32 m0, s84, 4096
    s_nop 0
    buffer_load_dwordx4 v20, s[48:51], s58 offen lds
    s_add_u32 s58, s58, 16384
    s_add_u32 m0, s84, 5120
    s_nop 0
    buffer_load_dwordx4 v20, s[48:51], s58 offen lds
    s_add_u32 s58, s58, 16384
    v_mfma_f32_32x32x16_bf16 v[64:79], v[32:35], a[16:19], v[64:79]
    v_mfma_f32_32x32x16_bf16 v[80:95], v[36:39], a[16:19], v[80:95]
    v_mfma_f32_32x32x16_bf16 v[96:111], v[32:35], a[20:23], v[96:111]
    v_mfma_f32_32x32x16_bf16 v[112:127], v[36:39], a[20:23], v[112:127]
    buffer_load_dwordx2 v[30:31], v27, s[40:43], s79 offen sc1
    s_waitcnt lgkmcnt(0)
    s_add_u32 m0, s84, 0
    s_nop 0
    buffer_load_dwordx4 v20, s[48:51], s58 offen lds
    s_add_u32 s58, s58, 16384
    s_add_u32 m0, s84, 1024
    s_nop 0
    buffer_load_dwordx4 v20, s[48:51], s58 offen lds
    s_add_u32 s58, s58, 16384
    v_mfma_f32_32x32x16_bf16 v[64:79], v[40:43], a[24:27], v[64:79]
    v_mfma_f32_32x32x16_bf16 v[80:95], v[44:47], a[24:27], v[80:95]
    v_mfma_f32_32x32x16_bf16 v[96:111], v[40:43], a[28:31], v[96:111]
    v_mfma_f32_32x32x16_bf16 v[112:127], v[44:47], a[28:31], v[112:127]
    s_setprio 2
    s_waitcnt vmcnt(6)
    ds_read_b64_tr_b16 a[0:1], v21 offset:2048
    ds_read_b64_tr_b16 a[2:3], v21 offset:2560
    s_waitcnt vmcnt(5)
    ds_read_b64_tr_b16 a[4:5], v21 offset:3072
    ds_read_b64_tr_b16 a[6:7], v21 offset:3584
    s_waitcnt lgkmcnt(2)
    s_add_u32 m0, s84, 2048
    s_nop 0
    buffer_load_dwordx4 v20, s[48:51], s58 offen lds
    s_add_u32 s58, s58, 16384
    s_waitcnt vmcnt(5)
    ds_read_b64_tr_b16 a[8:9], v21 offset:4096
    ds_read_b64_tr_b16 a[10:11], v21 offset:4608
    s_waitcnt lgkmcnt(2)
    s_add_u32 m0, s84, 3072
    s_nop 0
    buffer_load_dwordx4 v20, s[48:51], s58 offen lds
    s_add_u32 s58, s58, 16384
    ds_read_b32 v12, v3 offset:0
    s_waitcnt vmcnt(4)
    s_mov_b32 s78, 0
    v_cmp_ne_u64 vcc, s[10:11], v[30:31]
    s_cbranch_vccnz B_slow
    s_waitcnt lgkmcnt(0)
    v_cmp_gt_u32 vcc, 4, v12
    s_cbranch_vccnz B_slow
    s_add_u32 m0, s74, 0
    s_add_u32 s56, s73, 0
    buffer_load_dwordx4 v2, s[40:43], s56 offen offset:0 sc1 lds
    buffer_load_dwordx4 v2, s[40:43], s56 offen offset:1024 sc1 lds
    buffer_load_dwordx4 v2, s[40:43], s56 offen offset:2048 sc1 lds
    buffer_load_dwordx4 v2, s[40:43], s56 offen offset:3072 sc1 lds
    s_add_u32 m0, s74, 32768
    s_add_u32 s56, s73, 32768
    buffer_load_dwordx4 v2, s[40:43], s56 offen offset:0 sc1 lds
    buffer_load_dwordx4 v2, s[40:43], s56 offen offset:1024 sc1 lds
    buffer_load_dwordx4 v2, s[40:43], s56 offen offset:2048 sc1 lds
    buffer_load_dwordx4 v2, s[40:43], s56 offen offset:3072 sc1 lds
    s_add_u32 m0, s74, 4096
    s_add_u32 s56, s73, 4096
    buffer_load_dwordx4 v2, s[40:43], s56 offen offset:0 sc1 lds
    buffer_load_dwordx4 v2, s[40:43], s56 offen offset:1024 sc1 lds
    buffer_load_dwordx4 v2, s[40:43], s56 offen offset:2048 sc1 lds
    buffer_load_dwordx4 v2, s[40:43], s56 offen offset:3072 sc1 lds
    s_add_u32 m0, s74, 36864
    s_add_u32 s56, s73, 36864
    buffer_load_dwordx4 v2, s[40:43], s56 offen offset:0 sc1 lds
    buffer_load_dwordx4 v2, s[40:43], s56 offen offset:1024 sc1 lds
    buffer_load_dwordx4 v2, s[40:43], s56 offen offset:2048 sc1 lds
    buffer_load_dwordx4 v2, s[40:43], s56 offen offset:3072 sc1 lds
    s_mov_b32 s78, 1
B_slow:
    s_setprio 2
Lw_17:
    ds_read_b32 v12, v3 offset:24
    s_waitcnt lgkmcnt(0)
    v_cmp_gt_u32 vcc, 4, v12
    s_cbranch_vccz Lwd_18
    s_sleep 16
    s_sub_u32 s3, s3, 1
    s_cbranch_scc0 Lw_17
    s_mov_b32 s3, 0
Lwd_18:
    s_cmp_lg_u32 s52, 0
    s_cbranch_scc1 Lr_19
    ds_write_b128 v2, v[80:83] offset:21504
    ds_write_b128 v2, v[84:87] offset:22528
    ds_write_b128 v2, v[88:91] offset:23552
    ds_write_b128 v2, v[92:95] offset:24576
    ds_write_b128 v2, v[96:99] offset:29696
    ds_write_b128 v2, v[100:103] offset:30720
    ds_write_b128 v2, v[104:107] offset:31744
    ds_write_b128 v2, v[108:111] offset:32768
    ds_write_b128 v2, v[112:115] offset:37888
    ds_write_b128 v2, v[116:119] offset:38912
    ds_write_b128 v2, v[120:123] offset:39936
    ds_write_b128 v2, v[124:127] offset:40960
    v_mov_b32 v32, v64
    v_mov_b32 v33, v65
    v_mov_b32 v34, v66
    v_mov_b32 v35, v67
    v_mov_b32 v36, v68
    v_mov_b32 v37, v69
    v_mov_b32 v38, v70
    v_mov_b32 v39, v71
    v_mov_b32 v40, v72
    v_mov_b32 v41, v73
    v_mov_b32 v42, v74
    v_mov_b32 v43, v75
    v_mov_b32 v44, v76
    v_mov_b32 v45, v77
    v_mov_b32 v46, v78
    v_mov_b32 v47, v79
Lr_19:
    s_cmp_lg_u32 s52, 1
    s_cbranch_scc1 Lr_20
    ds_write_b128 v2, v[64:67] offset:1024
    ds_write_b128 v2, v[68:71] offset:2048
    ds_write_b128 v2, v[72:75] offset:3072
    ds_write_b128 v2, v[76:79] offset:4096
    ds_write_b128 v2, v[96:99] offset:33792
    ds_write_b128 v2, v[100:103] offset:34816
    ds_write_b128 v2, v[104:107] offset:35840
    ds_write_b128 v2, v[108:111] offset:36864
    ds_write_b128 v2, v[112:115] offset:41984
    ds_write_b128 v2, v[116:119] offset:43008
    ds_write_b128 v2, v[120:123] offset:44032
    ds_write_b128 v2, v[124:127] offset:45056
    v_mov_b32 v32, v80
    v_mov_b32 v33, v81
    v_mov_b32 v34, v82
    v_mov_b32 v35, v83
    v_mov_b32 v36, v84
    v_mov_b32 v37, v85
    v_mov_b32 v38, v86
    v_mov_b32 v39, v87
    v_mov_b32 v40, v88
    v_mov_b32 v41, v89
    v_mov_b32 v42, v90
    v_mov_b32 v43, v91
    v_mov_b32 v44, v92
    v_mov_b32 v45, v93
    v_mov_b32 v46, v94
    v_mov_b32 v47, v95
Lr_20:
    s_cmp_lg_u32 s52, 2
    s_cbranch_scc1 Lr_21
    ds_write_b128 v2, v[64:67] offset:5120
    ds_write_b128 v2, v[68:71] offset:6144
    ds_write_b128 v2, v[72:75] offset:7168
    ds_write_b128 v2, v[76:79] offset:8192
    ds_write_b128 v2, v[80:83] offset:13312
    ds_write_b128 v2, v[84:87] offset:14336
    ds_write_b128 v2, v[88:91] offset:15360
    ds_write_b128 v2, v[92:95] offset:16384
    ds_write_b128 v2, v[112:115] offset:46080
    ds_write_b128 v2, v[116:119] offset:47104
    ds_write_b128 v2, v[120:123] offset:48128
    ds_write_b128 v2, v[124:127] offset:49152
    v_mov_b32 v32, v96
    v_mov_b32 v33, v97
    v_mov_b32 v34, v98
    v_mov_b32 v35, v99
    v_mov_b32 v36, v100
    v_mov_b32 v37, v101
    v_mov_b32 v38, v102
    v_mov_b32 v39, v103
    v_mov_b32 v40, v104
    v_mov_b32 v41, v105
    v_mov_b32 v42, v106
    v_mov_b32 v43, v107
    v_mov_b32 v44, v108
    v_mov_b32 v45, v109
    v_mov_b32 v46, v110
    v_mov_b32 v47, v111
Lr_21:
    s_cmp_lg_u32 s52, 3
    s_cbranch_scc1 Lr_22
    ds_write_b128 v2, v[64:67] offset:9216
    ds_write_b128 v2, v[68:71] offset:10240
    ds_write_b128 v2, v[72:75] offset:11264
    ds_write_b128 v2, v[76:79] offset:12288
    ds_write_b128 v2, v[80:83] offset:17408
    ds_write_b128 v2, v[84:87] offset:18432
    ds_write_b128 v2, v[88:91] offset:19456
    ds_write_b128 v2, v[92:95] offset:20480
    ds_write_b128 v2, v[96:99] offset:25600
    ds_write_b128 v2, v[100:103] offset:26624
    ds_write_b128 v2, v[104:107] offset:27648
    ds_write_b128 v2, v[108:111] offset:28672
    v_mov_b32 v32, v112
    v_mov_b32 v33, v113
    v_mov_b32 v34, v114
    v_mov_b32 v35, v115
    v_mov_b32 v36, v116
    v_mov_b32 v37, v117
    v_mov_b32 v38, v118
    v_mov_b32 v39, v119
    v_mov_b32 v40, v120
    v_mov_b32 v41, v121
    v_mov_b32 v42, v122
    v_mov_b32 v43, v123
    v_mov_b32 v44, v124
    v_mov_b32 v45, v125
    v_mov_b32 v46, v126
    v_mov_b32 v47, v127
Lr_22:
    s_mov_b64 exec, 1
    ds_add_u32 v3, v4 offset:28
    s_mov_b64 exec, -1
    s_cmp_eq_u32 s78, 1
    s_cbranch_scc1 B_odone
Lw_23:
    ds_read_b32 v14, v3 offset:0
    s_waitcnt lgkmcnt(0)
    v_cmp_gt_u32 vcc, 4, v14
    s_cbranch_vccz Lwd_24
    s_sleep 4
    s_sub_u32 s3, s3, 1
    s_cbranch_scc0 Lw_23
    s_mov_b32 s3, 0
Lwd_24:
    s_mov_b32 s59, 0x1400000
Lp_25:
    buffer_load_dwordx2 v[14:15], v27, s[40:43], s59 offen sc1
    s_waitcnt vmcnt(0)
    v_cmp_ne_u64 vcc, s[10:11], v[14:15]
    s_cbranch_vccz Lpd_26
    s_sleep 1
    s_sub_u32 s3, s3, 1
    s_cbranch_scc0 Lp_25
    s_mov_b32 s3, 0
Lpd_26:
    s_add_u32 m0, s74, 0
    s_add_u32 s56, s73, 0
    buffer_load_dwordx4 v2, s[40:43], s56 offen offset:0 sc1 lds
    buffer_load_dwordx4 v2, s[40:43], s56 offen offset:1024 sc1 lds
    buffer_load_dwordx4 v2, s[40:43], s56 offen offset:2048 sc1 lds
    buffer_load_dwordx4 v2, s[40:43], s56 offen offset:3072 sc1 lds
    s_add_u32 m0, s74, 32768
    s_add_u32 s56, s73, 32768
    buffer_load_dwordx4 v2, s[40:43], s56 offen offset:0 sc1 lds
    buffer_load_dwordx4 v2, s[40:43], s56 offen offset:1024 sc1 lds
    buffer_load_dwordx4 v2, s[40:43], s56 offen offset:2048 sc1 lds
    buffer_load_dwordx4 v2, s[40:43], s56 offen offset:3072 sc1 lds
    s_add_u32 m0, s74, 4096
    s_add_u32 s56, s73, 4096
    buffer_load_dwordx4 v2, s[40:43], s56 offen offset:0 sc1 lds
    buffer_load_dwordx4 v2, s[40:43], s56 offen offset:1024 sc1 lds
    buffer_load_dwordx4 v2, s[40:43], s56 offen offset:2048 sc1 lds
    buffer_load_dwordx4 v2, s[40:43], s56 offen offset:3072 sc1 lds
    s_add_u32 m0, s74, 36864
    s_add_u32 s56, s73, 36864
    buffer_load_dwordx4 v2, s[40:43], s56 offen offset:0 sc1 lds
    buffer_load_dwordx4 v2, s[40:43], s56 offen offset:1024 sc1 lds
    buffer_load_dwordx4 v2, s[40:43], s56 offen offset:2048 sc1 lds
    buffer_load_dwordx4 v2, s[40:43], s56 offen offset:3072 sc1 lds
B_odone:
    s_waitcnt vmcnt(16)
    ds_read_b64_tr_b16 a[12:13], v21 offset:5120
    ds_read_b64_tr_b16 a[14:15], v21 offset:5632
    ds_read_b64_tr_b16 a[16:17], v21 offset:0
    ds_read_b64_tr_b16 a[18:19], v21 offset:512
    ds_read_b64_tr_b16 a[20:21], v21 offset:1024
    ds_read_b64_tr_b16 a[22:23], v21 offset:1536
    ds_read_b64_tr_b16 a[24:25], v21 offset:2048
    ds_read_b64_tr_b16 a[26:27], v21 offset:2560
    ds_read_b64_tr_b16 a[28:29], v21 offset:3072
    ds_read_b64_tr_b16 a[30:31], v21 offset:3584
Lw_27:
    ds_read_b32 v12, v3 offset:28
    s_waitcnt lgkmcnt(0)
    v_cmp_gt_u32 vcc, 4, v12
    s_cbranch_vccz Lwd_28
    s_sleep 1
    s_sub_u32 s3, s3, 1
    s_cbranch_scc0 Lw_27
    s_mov_b32 s3, 0
Lwd_28:
    s_mul_i32 s56, s52, 12288
    v_add_u32 v12, s56, v2
    ds_read_b128 v[64:67], v12 offset:1024
    ds_read_b128 v[68:71], v12 offset:2048
    ds_read_b128 v[72:75], v12 offset:3072
    ds_read_b128 v[76:79], v12 offset:4096
    ds_read_b128 v[80:83], v12 offset:5120
    ds_read_b128 v[84:87], v12 offset:6144
    ds_read_b128 v[88:91], v12 offset:7168
    ds_read_b128 v[92:95], v12 offset:8192
    ds_read_b128 v[96:99], v12 offset:9216
    ds_read_b128 v[100:103], v12 offset:10240
    ds_read_b128 v[104:107], v12 offset:11264
    ds_read_b128 v[108:111], v12 offset:12288
    s_waitcnt lgkmcnt(0)
    v_pk_add_f32 v[32:33], v[32:33], v[64:65]
    v_pk_add_f32 v[80:81], v[80:81], v[96:97]
    v_pk_add_f32 v[34:35], v[34:35], v[66:67]
    v_pk_add_f32 v[82:83], v[82:83], v[98:99]
    v_pk_add_f32 v[36:37], v[36:37], v[68:69]
    v_pk_add_f32 v[84:85], v[84:85], v[100:101]
    v_pk_add_f32 v[38:39], v[38:39], v[70:71]
    v_pk_add_f32 v[86:87], v[86:87], v[102:103]
    v_pk_add_f32 v[40:41], v[40:41], v[72:73]
    v_pk_add_f32 v[88:89], v[88:89], v[104:105]
    v_pk_add_f32 v[42:43], v[42:43], v[74:75]
    v_pk_add_f32 v[90:91], v[90:91], v[106:107]
    v_pk_add_f32 v[44:45], v[44:45], v[76:77]
    v_pk_add_f32 v[92:93], v[92:93], v[108:109]
    v_pk_add_f32 v[46:47], v[46:47], v[78:79]
    v_pk_add_f32 v[94:95], v[94:95], v[110:111]
    v_pk_add_f32 v[32:33], v[32:33], v[80:81]
    v_pk_add_f32 v[34:35], v[34:35], v[82:83]
    v_pk_add_f32 v[36:37], v[36:37], v[84:85]
    v_pk_add_f32 v[38:39], v[38:39], v[86:87]
    v_pk_add_f32 v[40:41], v[40:41], v[88:89]
    v_pk_add_f32 v[42:43], v[42:43], v[90:91]
    v_pk_add_f32 v[44:45], v[44:45], v[92:93]
    v_pk_add_f32 v[46:47], v[46:47], v[94:95]
    v_sub_f32 v17, 1.0, v25
    v_lshlrev_b32 v12, 16, v56
    v_and_b32 v13, 0xffff0000, v56
    v_lshlrev_b32 v14, 16, v57
    v_and_b32 v15, 0xffff0000, v57
    v_fmac_f32 v32, v17, v12
    v_fmac_f32 v33, v17, v13
    v_fmac_f32 v34, v17, v14
    v_fmac_f32 v35, v17, v15
    v_lshlrev_b32 v12, 16, v58
    v_and_b32 v13, 0xffff0000, v58
    v_lshlrev_b32 v14, 16, v59
    v_and_b32 v15, 0xffff0000, v59
    v_fmac_f32 v36, v17, v12
    v_fmac_f32 v37, v17, v13
    v_fmac_f32 v38, v17, v14
    v_fmac_f32 v39, v17, v15
    v_lshlrev_b32 v12, 16, v60
    v_and_b32 v13, 0xffff0000, v60
    v_lshlrev_b32 v14, 16, v61
    v_and_b32 v15, 0xffff0000, v61
    v_fmac_f32 v40, v17, v12
    v_fmac_f32 v41, v17, v13
    v_fmac_f32 v42, v17, v14
    v_fmac_f32 v43, v17, v15
    v_lshlrev_b32 v12, 16, v62
    v_and_b32 v13, 0xffff0000, v62
    v_lshlrev_b32 v14, 16, v63
    v_and_b32 v15, 0xffff0000, v63
    v_fmac_f32 v44, v17, v12
    v_fmac_f32 v45, v17, v13
    v_fmac_f32 v46, v17, v14
    v_fmac_f32 v47, v17, v15
    s_waitcnt vmcnt(8)
    s_barrier
    ds_read_b128 v[80:83], v28 offset:0
    ds_read_b128 v[84:87], v28 offset:1024
    ds_read_b128 v[88:91], v28 offset:2048
    ds_read_b128 v[92:95], v28 offset:3072
    ds_read_b128 v[96:99], v28 offset:8192
    ds_read_b128 v[100:103], v28 offset:9216
    ds_read_b128 v[104:107], v28 offset:10240
    ds_read_b128 v[108:111], v28 offset:11264
    ds_read_b128 v[112:115], v28 offset:16384
    ds_read_b128 v[116:119], v28 offset:17408
    ds_read_b128 v[120:123], v28 offset:18432
    ds_read_b128 v[124:127], v28 offset:19456
    s_waitcnt lgkmcnt(11)
    v_mfma_f32_32x32x16_bf16 v[64:79], a[0:3], v[80:83], 0
    ds_read_b128 v[80:83], v28 offset:24576
    s_waitcnt lgkmcnt(11)
    v_mfma_f32_32x32x16_bf16 v[64:79], a[4:7], v[84:87], v[64:79]
    ds_read_b128 v[84:87], v28 offset:25600
    s_waitcnt lgkmcnt(11)
    v_mfma_f32_32x32x16_bf16 v[64:79], a[8:11], v[88:91], v[64:79]
    ds_read_b128 v[88:91], v28 offset:26624
    s_waitcnt lgkmcnt(11)
    v_mfma_f32_32x32x16_bf16 v[64:79], a[12:15], v[92:95], v[64:79]
    ds_read_b128 v[92:95], v28 offset:27648
    s_waitcnt lgkmcnt(11)
    v_mfma_f32_32x32x16_bf16 v[64:79], a[32:35], v[96:99], v[64:79]
    s_waitcnt lgkmcnt(10)
    v_mfma_f32_32x32x16_bf16 v[64:79], a[36:39], v[100:103], v[64:79]
    s_waitcnt lgkmcnt(9)
    v_mfma_f32_32x32x16_bf16 v[64:79], a[40:43], v[104:107], v[64:79]
    s_waitcnt lgkmcnt(8)
    v_mfma_f32_32x32x16_bf16 v[64:79], a[44:47], v[108:111], v[64:79]
    s_waitcnt vmcnt(0)
    s_barrier
    s_waitcnt lgkmcnt(7)
    v_mfma_f32_32x32x16_bf16 v[64:79], a[64:67], v[112:115], v[64:79]
    ds_read_b128 v[96:99], v28 offset:4096
    ds_read_b128 v[100:103], v28 offset:5120
    s_waitcnt lgkmcnt(8)
    v_mfma_f32_32x32x16_bf16 v[64:79], a[68:71], v[116:119], v[64:79]
    ds_read_b128 v[104:107], v28 offset:6144
    ds_read_b128 v[108:111], v28 offset:7168
    s_waitcnt lgkmcnt(9)
    v_mfma_f32_32x32x16_bf16 v[64:79], a[72:75], v[120:123], v[64:79]
    ds_read_b128 v[112:115], v28 offset:12288
    ds_read_b128 v[116:119], v28 offset:13312
    s_waitcnt lgkmcnt(10)
    v_mfma_f32_32x32x16_bf16 v[64:79], a[76:79], v[124:127], v[64:79]
    ds_read_b128 v[120:123], v28 offset:14336
    ds_read_b128 v[124:127], v28 offset:15360
    s_waitcnt lgkmcnt(11)
    v_mfma_f32_32x32x16_bf16 v[64:79], a[96:99], v[80:83], v[64:79]
    ds_read_b128 v[80:83], v28 offset:20480
    s_waitcnt lgkmcnt(11)
    v_mfma_f32_32x32x16_bf16 v[64:79], a[100:103], v[84:87], v[64:79]
    ds_read_b128 v[84:87], v28 offset:21504
    s_waitcnt lgkmcnt(11)
    v_mfma_f32_32x32x16_bf16 v[64:79], a[104:107], v[88:91], v[64:79]
    ds_read_b128 v[88:91], v28 offset:22528
    s_waitcnt lgkmcnt(11)
    v_mfma_f32_32x32x16_bf16 v[64:79], a[108:111], v[92:95], v[64:79]
    ds_read_b128 v[92:95], v28 offset:23552
    s_waitcnt lgkmcnt(11)
    v_mfma_f32_32x32x16_bf16 v[64:79], a[16:19], v[96:99], v[64:79]
    ds_read_b128 v[96:99], v28 offset:28672
    s_waitcnt lgkmcnt(11)
    v_mfma_f32_32x32x16_bf16 v[64:79], a[20:23], v[100:103], v[64:79]
    ds_read_b128 v[100:103], v28 offset:29696
    s_waitcnt lgkmcnt(11)
    v_mfma_f32_32x32x16_bf16 v[64:79], a[24:27], v[104:107], v[64:79]
    ds_read_b128 v[104:107], v28 offset:30720
    s_waitcnt lgkmcnt(11)
    v_mfma_f32_32x32x16_bf16 v[64:79], a[28:31], v[108:111], v[64:79]
    ds_read_b128 v[108:111], v28 offset:31744
    s_waitcnt lgkmcnt(11)
    v_mfma_f32_32x32x16_bf16 v[64:79], a[48:51], v[112:115], v[64:79]
    s_waitcnt lgkmcnt(10)
    v_mfma_f32_32x32x16_bf16 v[64:79], a[52:55], v[116:119], v[64:79]
    s_waitcnt lgkmcnt(9)
    v_mfma_f32_32x32x16_bf16 v[64:79], a[56:59], v[120:123], v[64:79]
    s_waitcnt lgkmcnt(8)
    v_mfma_f32_32x32x16_bf16 v[64:79], a[60:63], v[124:127], v[64:79]
    s_waitcnt lgkmcnt(7)
    v_mfma_f32_32x32x16_bf16 v[64:79], a[80:83], v[80:83], v[64:79]
    s_waitcnt lgkmcnt(6)
    v_mfma_f32_32x32x16_bf16 v[64:79], a[84:87], v[84:87], v[64:79]
    s_waitcnt lgkmcnt(5)
    v_mfma_f32_32x32x16_bf16 v[64:79], a[88:91], v[88:91], v[64:79]
    s_waitcnt lgkmcnt(4)
    v_mfma_f32_32x32x16_bf16 v[64:79], a[92:95], v[92:95], v[64:79]
    s_waitcnt lgkmcnt(3)
    v_mfma_f32_32x32x16_bf16 v[64:79], a[112:115], v[96:99], v[64:79]
    s_waitcnt lgkmcnt(2)
    v_mfma_f32_32x32x16_bf16 v[64:79], a[116:119], v[100:103], v[64:79]
    s_waitcnt lgkmcnt(1)
    v_mfma_f32_32x32x16_bf16 v[64:79], a[120:123], v[104:107], v[64:79]
    s_waitcnt lgkmcnt(0)
    v_mfma_f32_32x32x16_bf16 v[64:79], a[124:127], v[108:111], v[64:79]
    s_nop 11
    v_fmac_f32 v32, v25, v64
    v_fmac_f32 v33, v25, v65
    v_fmac_f32 v34, v25, v66
    v_fmac_f32 v35, v25, v67
    v_fmac_f32 v36, v25, v68
    v_fmac_f32 v37, v25, v69
    v_fmac_f32 v38, v25, v70
    v_fmac_f32 v39, v25, v71
    v_fmac_f32 v40, v25, v72
    v_fmac_f32 v41, v25, v73
    v_fmac_f32 v42, v25, v74
    v_fmac_f32 v43, v25, v75
    v_fmac_f32 v44, v25, v76
    v_fmac_f32 v45, v25, v77
    v_fmac_f32 v46, v25, v78
    v_fmac_f32 v47, v25, v79
    v_cvt_pk_bf16_f32 v56, v32, v33
    v_cvt_pk_bf16_f32 v57, v34, v35
    v_cvt_pk_bf16_f32 v58, v36, v37
    v_cvt_pk_bf16_f32 v59, v38, v39
    v_cvt_pk_bf16_f32 v60, v40, v41
    v_cvt_pk_bf16_f32 v61, v42, v43
    v_cvt_pk_bf16_f32 v62, v44, v45
    v_cvt_pk_bf16_f32 v63, v46, v47
    s_nop 1
    v_permlane32_swap_b32 v56, v58
    v_permlane32_swap_b32 v57, v59
    v_permlane32_swap_b32 v60, v62
    v_permlane32_swap_b32 v61, v63
    s_nop 1
    buffer_store_dwordx4 v[56:59], v26, s[32:35], s75 offen offset:0
    buffer_store_dwordx4 v[60:63], v26, s[32:35], s75 offen offset:32
    s_endpgm
L_A:
    s_setprio 3
    s_lshl_b32 s85, s53, 6
    s_add_u32 s85, s85, s55
    s_waitcnt lgkmcnt(0)
    s_mov_b32 s40, s26
    s_mov_b32 s41, s27
    s_mov_b32 s42, 0x2800000
    s_mov_b32 s43, 0x00020000
    s_mov_b32 s48, s24
    s_mov_b32 s49, s25
    s_mov_b32 s50, 0x100
    s_mov_b32 s51, 0x00020000
    s_mov_b32 s28, s20
    s_mov_b32 s29, s21
    s_mov_b32 s30, 0x400
    s_mov_b32 s31, 0x00020000
    s_mov_b32 s32, s14
    s_mov_b32 s33, s15
    s_mov_b32 s34, 0xe00
    s_mov_b32 s35, 0x00020000
    s_mov_b32 s36, s12
    s_mov_b32 s37, s13
    s_mov_b32 s38, 0x1c0000
    s_mov_b32 s39, 0x00020000
    s_cmp_lg_u32 s52, 3
    s_cbranch_scc1 A_pkd
    s_mov_b32 m0, 256
    s_mul_i32 s59, s53, 224
    buffer_load_dwordx4 v2, s[28:31], 0 offen lds
    s_mov_b32 m0, 1280
    s_mov_b64 exec, 0x3fff
    buffer_load_dwordx4 v2, s[32:35], s59 offen lds
    s_mov_b64 exec, -1
    s_cmp_lg_u32 s2, 0
    s_cbranch_scc1 A_pkd
    s_memrealtime s[76:77]
    s_waitcnt lgkmcnt(0)
    s_or_b32 s76, s76, 1
    v_mov_b32 v18, s76
    v_mov_b32 v19, s77
    s_mov_b64 exec, 1
    buffer_store_dwordx2 v[18:19], v3, s[48:51], 0 offen sc1
    s_mov_b64 exec, -1
A_pkd:
    v_lshrrev_b32 v12, 5, v1
    v_and_b32 v13, 31, v1
    v_bfe_u32 v14, v1, 1, 3
    v_xor_b32 v14, v14, v12
    v_lshlrev_b32 v14, 4, v14
    v_lshl_add_u32 v5, v13, 7, v14
    s_lshl_b32 s56, s52, 12
    s_add_u32 s56, s56, 12288
    v_add_u32 v5, s56, v5
    v_xor_b32 v6, 32, v5
    v_xor_b32 v7, 64, v5
    v_xor_b32 v8, 96, v5
    v_bfe_u32 v14, v1, 2, 2
    v_lshlrev_b32 v14, 6, v14
    v_bfe_u32 v15, v1, 4, 1
    v_lshl_add_u32 v14, v15, 5, v14
    v_and_b32 v15, 3, v1
    v_lshl_add_u32 v14, v15, 3, v14
    v_lshl_add_u32 v9, v12, 9, v14
    v_add_u32 v10, 0x10000, v9
    v_add_u32 v11, 0x20000, v9
    v_lshrrev_b32 v16, 1, v1
    v_mul_u32_u24 v16, 2080, v16
    v_and_b32 v17, 1, v1
    v_lshl_add_u32 v29, v17, 4, v16
    v_mov_b32 v18, 0x3f803f80
    v_cmp_eq_u32 vcc, 0, v17
    v_lshlrev_b32 v19, 2, v1
    s_nop 0
    v_cndmask_b32 v36, 0, v18, vcc
    v_cndmask_b32 v37, 0, v18, vcc
    v_cndmask_b32 v38, 0, v18, vcc
    v_cndmask_b32 v39, 0, v18, vcc
    ds_write_b32 v19, v3
    v_and_b32 v14, 0x33, v1
    v_bfe_u32 v15, v1, 2, 1
    v_lshl_or_b32 v14, v15, 3, v14
    v_bfe_u32 v15, v1, 3, 1
    v_lshl_or_b32 v14, v15, 2, v14
    v_lshlrev_b32 v20, 4, v14
    v_and_b32 v14, 15, v1
    v_lshl_add_u32 v16, v12, 4, v14
    v_lshlrev_b32 v16, 4, v16
    v_bfe_u32 v15, v1, 4, 1
    v_lshl_add_u32 v21, v15, 17, v16
    v_add_u32 v26, 1280, v16
    v_add_u32 v27, 1792, v16
    v_and_b32 v17, 27, v1
    v_mov_b32 v18, 2320
    v_mov_b32 v19, 2304
    v_cmp_eq_u32 vcc, 16, v17
    v_add_u32 v25, 256, v2
    v_mov_b32 v28, 0xdddddddd
    v_cndmask_b32 v18, v18, v19, vcc
    v_cmp_eq_u32 vcc, 1, v15
    s_nop 1
    v_cndmask_b32 v26, v26, v18, vcc
    v_cndmask_b32 v27, v27, v18, vcc
    v_lshrrev_b32 v16, 2, v1
    v_and_b32 v17, 3, v1
    v_lshlrev_b32 v17, 4, v17
    v_mul_u32_u24 v30, 3584, v16
    v_add_u32 v30, v30, v17
    v_lshlrev_b32 v31, 6, v14
    v_lshl_add_u32 v31, v15, 3, v31
    s_lshl_b32 s86, s52, 10
    s_add_u32 s56, s86, 73760
    v_add_u32 v31, s56, v31
    v_lshlrev_b32 v34, 1, v14
    s_lshl_b32 s56, s52, 5
    v_add_u32 v34, s56, v34
    s_mul_i32 s84, s52, 57344
    s_mul_i32 s56, s53, 224
    s_add_u32 s84, s84, s56
    s_mul_i32 s56, s53, 3
    s_add_u32 s57, s56, 0
    s_and_b32 s58, s57, 15
    s_lshl_b32 s58, s58, 17
    s_lshl_b32 s59, s55, 10
    s_add_u32 s58, s58, s59
    s_lshl_b32 s59, s58, 1
    s_add_u32 s59, s59, 0x200000
    s_cmp_lt_u32 s57, 16
    s_cselect_b32 s72, 0x3eb8aa3b, 1.0
    s_cselect_b32 s75, s58, s59
    s_cselect_b32 s58, 16, 17
    s_lshl_b32 s58, 1, s58
    s_add_u32 s78, s75, s58
    s_add_u32 s57, s56, 1
    s_and_b32 s58, s57, 15
    s_lshl_b32 s58, s58, 17
    s_lshl_b32 s59, s55, 10
    s_add_u32 s58, s58, s59
    s_lshl_b32 s59, s58, 1
    s_add_u32 s59, s59, 0x200000
    s_cmp_lt_u32 s57, 16
    s_cselect_b32 s73, 0x3eb8aa3b, 1.0
    s_cselect_b32 s76, s58, s59
    s_cselect_b32 s58, 16, 17
    s_lshl_b32 s58, 1, s58
    s_add_u32 s79, s76, s58
    s_add_u32 s57, s56, 2
    s_and_b32 s58, s57, 15
    s_lshl_b32 s58, s58, 17
    s_lshl_b32 s59, s55, 10
    s_add_u32 s58, s58, s59
    s_lshl_b32 s59, s58, 1
    s_add_u32 s59, s59, 0x200000
    s_cmp_lt_u32 s57, 16
    s_cselect_b32 s74, 0x3eb8aa3b, 1.0
    s_cselect_b32 s77, s58, s59
    s_cselect_b32 s58, 16, 17
    s_lshl_b32 s58, 1, s58
    s_add_u32 s80, s77, s58
    s_lshr_b32 s56, s68, 1
    s_add_u32 s57, s56, 16
    s_mul_i32 s57, s57, 43
    s_lshr_b32 s57, s57, 7
    s_lshl_b32 s57, s57, 6
    s_add_u32 s58, s56, 32
    s_mul_i32 s58, s58, 43
    s_lshr_b32 s58, s58, 7
    s_lshl_b32 s58, s58, 6
    s_mul_i32 s56, s56, 43
    s_lshr_b32 s56, s56, 7
    s_lshl_b32 s56, s56, 6
    s_lshl_b32 s59, s69, 3
    s_add_u32 s56, s56, s59
    s_lshl_b32 s59, s52, 1
    s_add_u32 s56, s56, s59
    v_and_b32 v16, 7, v1
    v_lshl_add_u32 v16, v16, 2, s52
    v_cmp_gt_u32 vcc, 20, v16
    v_mov_b32 v17, s52
    v_and_b32 v19, 1, v1
    v_cndmask_b32 v16, v17, v16, vcc
    v_add_u32 v17, s57, v16
    v_add_u32 v18, s58, v16
    v_add_u32 v19, s56, v19
    v_cmp_gt_u32 vcc, 8, v1
    s_nop 1
    v_cndmask_b32 v17, v18, v17, vcc
    v_cmp_gt_u32 vcc, 16, v1
    s_nop 1
    v_cndmask_b32 v17, v19, v17, vcc
    v_lshlrev_b32 v22, 8, v17
    s_waitcnt lgkmcnt(0)
    s_cmp_lt_u32 s53, 10
    s_cbranch_scc1 A_NNN
    s_cmp_eq_u32 s53, 10
    s_cbranch_scc1 A_NNV
    s_barrier
    ds_read_b128 a[0:3], v5 offset:0
    ds_read_b64_tr_b16 a[4:5], v10 offset:12288
    ds_read_b64_tr_b16 a[6:7], v10 offset:12544
    ds_read_b64_tr_b16 a[8:9], v10 offset:16384
    ds_read_b64_tr_b16 a[10:11], v10 offset:16640
    ds_read_b64_tr_b16 a[12:13], v10 offset:20480
    ds_read_b64_tr_b16 a[14:15], v10 offset:20736
    ds_read_b128 a[16:19], v6 offset:0
    ds_read_b64_tr_b16 a[20:21], v10 offset:13312
    ds_read_b64_tr_b16 a[22:23], v10 offset:13568
    ds_read_b64_tr_b16 a[24:25], v10 offset:17408
    ds_read_b64_tr_b16 a[26:27], v10 offset:17664
    ds_read_b64_tr_b16 a[28:29], v10 offset:21504
    ds_read_b64_tr_b16 a[30:31], v10 offset:21760
    ds_read_b128 a[32:35], v7 offset:0
    ds_read_b64_tr_b16 a[36:37], v10 offset:14336
    ds_read_b64_tr_b16 a[38:39], v10 offset:14592
    ds_read_b64_tr_b16 a[40:41], v10 offset:18432
    ds_read_b64_tr_b16 a[42:43], v10 offset:18688
    ds_read_b64_tr_b16 a[44:45], v10 offset:22528
    ds_read_b64_tr_b16 a[46:47], v10 offset:22784
    s_waitcnt lgkmcnt(14)
    v_mfma_f32_32x32x16_bf16 v[40:55], a[0:3], a[4:7], 0
    ds_read_b128 a[48:51], v8 offset:0
    ds_read_b64_tr_b16 a[52:53], v10 offset:15360
    ds_read_b64_tr_b16 a[54:55], v10 offset:15616
    v_mfma_f32_32x32x16_bf16 v[56:71], a[0:3], a[8:11], 0
    ds_read_b64_tr_b16 a[56:57], v10 offset:19456
    ds_read_b64_tr_b16 a[58:59], v10 offset:19712
    v_mfma_f32_32x32x16_bf16 v[72:87], a[0:3], a[12:15], 0
    ds_read_b64_tr_b16 a[60:61], v10 offset:23552
    ds_read_b64_tr_b16 a[62:63], v10 offset:23808
    s_waitcnt lgkmcnt(14)
    v_mfma_f32_32x32x16_bf16 v[40:55], a[16:19], a[20:23], v[40:55]
    v_mfma_f32_32x32x16_bf16 v[56:71], a[16:19], a[24:27], v[56:71]
    v_mfma_f32_32x32x16_bf16 v[72:87], a[16:19], a[28:31], v[72:87]
    s_waitcnt vmcnt(0)
    s_waitcnt lgkmcnt(0)
    s_barrier
    v_mfma_f32_32x32x16_bf16 v[40:55], a[32:35], a[36:39], v[40:55]
    ds_read_b128 a[64:67], v5 offset:16384
    ds_read_b64_tr_b16 a[68:69], v10 offset:24576
    ds_read_b64_tr_b16 a[70:71], v10 offset:24832
    ds_read_b64_tr_b16 a[72:73], v10 offset:28672
    v_mfma_f32_32x32x16_bf16 v[56:71], a[32:35], a[40:43], v[56:71]
    ds_read_b64_tr_b16 a[74:75], v10 offset:28928
    ds_read_b64_tr_b16 a[76:77], v10 offset:32768
    ds_read_b64_tr_b16 a[78:79], v10 offset:33024
    ds_read_b128 a[80:83], v6 offset:16384
    v_mfma_f32_32x32x16_bf16 v[72:87], a[32:35], a[44:47], v[72:87]
    ds_read_b64_tr_b16 a[84:85], v10 offset:25600
    ds_read_b64_tr_b16 a[86:87], v10 offset:25856
    ds_read_b64_tr_b16 a[88:89], v10 offset:29696
    ds_read_b64_tr_b16 a[90:91], v10 offset:29952
    v_mfma_f32_32x32x16_bf16 v[40:55], a[48:51], a[52:55], v[40:55]
    ds_read_b64_tr_b16 a[92:93], v10 offset:33792
    ds_read_b64_tr_b16 a[94:95], v10 offset:34048
    ds_read_b128 a[96:99], v7 offset:16384
    v_mfma_f32_32x32x16_bf16 v[56:71], a[48:51], a[56:59], v[56:71]
    ds_read_b64_tr_b16 a[100:101], v10 offset:26624
    ds_read_b64_tr_b16 a[102:103], v10 offset:26880
    ds_read_b64_tr_b16 a[104:105], v10 offset:30720
    v_mfma_f32_32x32x16_bf16 v[72:87], a[48:51], a[60:63], v[72:87]
    ds_read_b64_tr_b16 a[106:107], v10 offset:30976
    ds_read_b64_tr_b16 a[108:109], v10 offset:34816
    ds_read_b64_tr_b16 a[110:111], v10 offset:35072
    s_waitcnt lgkmcnt(14)
    v_mfma_f32_32x32x16_bf16 v[40:55], a[64:67], a[68:71], v[40:55]
    ds_read_b128 a[112:115], v8 offset:16384
    ds_read_b64_tr_b16 a[116:117], v10 offset:27648
    ds_read_b64_tr_b16 a[118:119], v10 offset:27904
    v_mfma_f32_32x32x16_bf16 v[56:71], a[64:67], a[72:75], v[56:71]
    ds_read_b64_tr_b16 a[120:121], v10 offset:31744
    ds_read_b64_tr_b16 a[122:123], v10 offset:32000
    v_mfma_f32_32x32x16_bf16 v[72:87], a[64:67], a[76:79], v[72:87]
    ds_read_b64_tr_b16 a[124:125], v10 offset:35840
    ds_read_b64_tr_b16 a[126:127], v10 offset:36096
    s_waitcnt lgkmcnt(14)
    v_mfma_f32_32x32x16_bf16 v[40:55], a[80:83], a[84:87], v[40:55]
    v_mfma_f32_32x32x16_bf16 v[56:71], a[80:83], a[88:91], v[56:71]
    v_mfma_f32_32x32x16_bf16 v[72:87], a[80:83], a[92:95], v[72:87]
    s_waitcnt lgkmcnt(0)
    s_barrier
    v_mfma_f32_32x32x16_bf16 v[40:55], a[96:99], a[100:103], v[40:55]
    ds_read_b128 a[0:3], v5 offset:32768
    ds_read_b64_tr_b16 a[4:5], v10 offset:36864
    ds_read_b64_tr_b16 a[6:7], v10 offset:37120
    ds_read_b64_tr_b16 a[8:9], v10 offset:40960
    v_mfma_f32_32x32x16_bf16 v[56:71], a[96:99], a[104:107], v[56:71]
    ds_read_b64_tr_b16 a[10:11], v10 offset:41216
    ds_read_b64_tr_b16 a[12:13], v10 offset:45056
    ds_read_b64_tr_b16 a[14:15], v10 offset:45312
    ds_read_b128 a[16:19], v6 offset:32768
    v_mfma_f32_32x32x16_bf16 v[72:87], a[96:99], a[108:111], v[72:87]
    ds_read_b64_tr_b16 a[20:21], v10 offset:37888
    ds_read_b64_tr_b16 a[22:23], v10 offset:38144
    ds_read_b64_tr_b16 a[24:25], v10 offset:41984
    ds_read_b64_tr_b16 a[26:27], v10 offset:42240
    v_mfma_f32_32x32x16_bf16 v[40:55], a[112:115], a[116:119], v[40:55]
    ds_read_b64_tr_b16 a[28:29], v10 offset:46080
    ds_read_b64_tr_b16 a[30:31], v10 offset:46336
    ds_read_b128 a[32:35], v7 offset:32768
    v_mfma_f32_32x32x16_bf16 v[56:71], a[112:115], a[120:123], v[56:71]
    ds_read_b64_tr_b16 a[36:37], v10 offset:38912
    ds_read_b64_tr_b16 a[38:39], v10 offset:39168
    ds_read_b64_tr_b16 a[40:41], v10 offset:43008
    v_mfma_f32_32x32x16_bf16 v[72:87], a[112:115], a[124:127], v[72:87]
    ds_read_b64_tr_b16 a[42:43], v10 offset:43264
    ds_read_b64_tr_b16 a[44:45], v10 offset:47104
    ds_read_b64_tr_b16 a[46:47], v10 offset:47360
    s_waitcnt lgkmcnt(14)
    v_mfma_f32_32x32x16_bf16 v[40:55], a[0:3], a[4:7], v[40:55]
    ds_read_b128 a[48:51], v8 offset:32768
    ds_read_b64_tr_b16 a[52:53], v10 offset:39936
    ds_read_b64_tr_b16 a[54:55], v10 offset:40192
    v_mfma_f32_32x32x16_bf16 v[56:71], a[0:3], a[8:11], v[56:71]
    ds_read_b64_tr_b16 a[56:57], v10 offset:44032
    ds_read_b64_tr_b16 a[58:59], v10 offset:44288
    v_mfma_f32_32x32x16_bf16 v[72:87], a[0:3], a[12:15], v[72:87]
    ds_read_b64_tr_b16 a[60:61], v10 offset:48128
    ds_read_b64_tr_b16 a[62:63], v10 offset:48384
    s_waitcnt lgkmcnt(14)
    v_mfma_f32_32x32x16_bf16 v[40:55], a[16:19], a[20:23], v[40:55]
    v_mfma_f32_32x32x16_bf16 v[56:71], a[16:19], a[24:27], v[56:71]
    v_mfma_f32_32x32x16_bf16 v[72:87], a[16:19], a[28:31], v[72:87]
    s_waitcnt lgkmcnt(0)
    s_barrier
    v_mfma_f32_32x32x16_bf16 v[40:55], a[32:35], a[36:39], v[40:55]
    ds_read_b128 a[64:67], v5 offset:49152
    ds_read_b64_tr_b16 a[68:69], v10 offset:12288
    ds_read_b64_tr_b16 a[70:71], v10 offset:12544
    ds_read_b64_tr_b16 a[72:73], v10 offset:16384
    v_mfma_f32_32x32x16_bf16 v[56:71], a[32:35], a[40:43], v[56:71]
    ds_read_b64_tr_b16 a[74:75], v10 offset:16640
    ds_read_b64_tr_b16 a[76:77], v10 offset:20480
    ds_read_b64_tr_b16 a[78:79], v10 offset:20736
    ds_read_b128 a[80:83], v6 offset:49152
    v_mfma_f32_32x32x16_bf16 v[72:87], a[32:35], a[44:47], v[72:87]
    ds_read_b64_tr_b16 a[84:85], v10 offset:13312
    ds_read_b64_tr_b16 a[86:87], v10 offset:13568
    ds_read_b64_tr_b16 a[88:89], v10 offset:17408
    ds_read_b64_tr_b16 a[90:91], v10 offset:17664
    v_mfma_f32_32x32x16_bf16 v[40:55], a[48:51], a[52:55], v[40:55]
    ds_read_b64_tr_b16 a[92:93], v10 offset:21504
    ds_read_b64_tr_b16 a[94:95], v10 offset:21760
    ds_read_b128 a[96:99], v7 offset:49152
    v_mfma_f32_32x32x16_bf16 v[56:71], a[48:51], a[56:59], v[56:71]
    ds_read_b64_tr_b16 a[100:101], v10 offset:14336
    ds_read_b64_tr_b16 a[102:103], v10 offset:14592
    ds_read_b64_tr_b16 a[104:105], v10 offset:18432
    v_mfma_f32_32x32x16_bf16 v[72:87], a[48:51], a[60:63], v[72:87]
    ds_read_b64_tr_b16 a[106:107], v10 offset:18688
    ds_read_b64_tr_b16 a[108:109], v10 offset:22528
    ds_read_b64_tr_b16 a[110:111], v10 offset:22784
    s_waitcnt lgkmcnt(14)
    v_mfma_f32_32x32x16_bf16 v[40:55], a[64:67], a[68:71], v[40:55]
    ds_read_b128 a[112:115], v8 offset:49152
    ds_read_b64_tr_b16 a[116:117], v10 offset:15360
    ds_read_b64_tr_b16 a[118:119], v10 offset:15616
    v_mfma_f32_32x32x16_bf16 v[56:71], a[64:67], a[72:75], v[56:71]
    ds_read_b64_tr_b16 a[120:121], v10 offset:19456
    ds_read_b64_tr_b16 a[122:123], v10 offset:19712
    v_mfma_f32_32x32x16_bf16 v[72:87], a[64:67], a[76:79], v[72:87]
    ds_read_b64_tr_b16 a[124:125], v10 offset:23552
    ds_read_b64_tr_b16 a[126:127], v10 offset:23808
    s_waitcnt lgkmcnt(14)
    v_mfma_f32_32x32x16_bf16 v[40:55], a[80:83], a[84:87], v[40:55]
    v_mfma_f32_32x32x16_bf16 v[56:71], a[80:83], a[88:91], v[56:71]
    v_mfma_f32_32x32x16_bf16 v[72:87], a[80:83], a[92:95], v[72:87]
    s_waitcnt lgkmcnt(0)
    s_barrier
    v_mfma_f32_32x32x16_bf16 v[40:55], a[96:99], a[100:103], v[40:55]
    ds_read_b128 a[0:3], v5 offset:0
    ds_read_b64_tr_b16 a[4:5], v10 offset:24576
    ds_read_b64_tr_b16 a[6:7], v10 offset:24832
    ds_read_b64_tr_b16 a[8:9], v10 offset:28672
    v_mfma_f32_32x32x16_bf16 v[56:71], a[96:99], a[104:107], v[56:71]
    ds_read_b64_tr_b16 a[10:11], v10 offset:28928
    ds_read_b64_tr_b16 a[12:13], v10 offset:32768
    ds_read_b64_tr_b16 a[14:15], v10 offset:33024
    ds_read_b128 a[16:19], v6 offset:0
    v_mfma_f32_32x32x16_bf16 v[72:87], a[96:99], a[108:111], v[72:87]
    ds_read_b64_tr_b16 a[20:21], v10 offset:25600
    ds_read_b64_tr_b16 a[22:23], v10 offset:25856
    ds_read_b64_tr_b16 a[24:25], v10 offset:29696
    ds_read_b64_tr_b16 a[26:27], v10 offset:29952
    v_mfma_f32_32x32x16_bf16 v[40:55], a[112:115], a[116:119], v[40:55]
    ds_read_b64_tr_b16 a[28:29], v10 offset:33792
    ds_read_b64_tr_b16 a[30:31], v10 offset:34048
    ds_read_b128 a[32:35], v7 offset:0
    v_mfma_f32_32x32x16_bf16 v[56:71], a[112:115], a[120:123], v[56:71]
    ds_read_b64_tr_b16 a[36:37], v10 offset:26624
    ds_read_b64_tr_b16 a[38:39], v10 offset:26880
    ds_read_b64_tr_b16 a[40:41], v10 offset:30720
    v_mfma_f32_32x32x16_bf16 v[72:87], a[112:115], a[124:127], v[72:87]
    ds_read_b64_tr_b16 a[42:43], v10 offset:30976
    ds_read_b64_tr_b16 a[44:45], v10 offset:34816
    ds_read_b64_tr_b16 a[46:47], v10 offset:35072
    s_waitcnt lgkmcnt(14)
    v_mfma_f32_32x32x16_bf16 v[40:55], a[0:3], a[4:7], v[40:55]
    ds_read_b128 a[48:51], v8 offset:0
    ds_read_b64_tr_b16 a[52:53], v10 offset:27648
    ds_read_b64_tr_b16 a[54:55], v10 offset:27904
    v_mfma_f32_32x32x16_bf16 v[56:71], a[0:3], a[8:11], v[56:71]
    ds_read_b64_tr_b16 a[56:57], v10 offset:31744
    ds_read_b64_tr_b16 a[58:59], v10 offset:32000
    v_mfma_f32_32x32x16_bf16 v[72:87], a[0:3], a[12:15], v[72:87]
    ds_read_b64_tr_b16 a[60:61], v10 offset:35840
    ds_read_b64_tr_b16 a[62:63], v10 offset:36096
    s_waitcnt lgkmcnt(14)
    v_mfma_f32_32x32x16_bf16 v[40:55], a[16:19], a[20:23], v[40:55]
    v_mfma_f32_32x32x16_bf16 v[56:71], a[16:19], a[24:27], v[56:71]
    v_mfma_f32_32x32x16_bf16 v[72:87], a[16:19], a[28:31], v[72:87]
    s_waitcnt lgkmcnt(0)
    s_barrier
    v_mfma_f32_32x32x16_bf16 v[40:55], a[32:35], a[36:39], v[40:55]
    ds_read_b128 a[64:67], v5 offset:16384
    ds_read_b64_tr_b16 a[68:69], v10 offset:36864
    ds_read_b64_tr_b16 a[70:71], v10 offset:37120
    ds_read_b64_tr_b16 a[72:73], v10 offset:40960
    v_mfma_f32_32x32x16_bf16 v[56:71], a[32:35], a[40:43], v[56:71]
    ds_read_b64_tr_b16 a[74:75], v10 offset:41216
    ds_read_b64_tr_b16 a[76:77], v10 offset:45056
    ds_read_b64_tr_b16 a[78:79], v10 offset:45312
    ds_read_b128 a[80:83], v6 offset:16384
    v_mfma_f32_32x32x16_bf16 v[72:87], a[32:35], a[44:47], v[72:87]
    ds_read_b64_tr_b16 a[84:85], v10 offset:37888
    ds_read_b64_tr_b16 a[86:87], v10 offset:38144
    ds_read_b64_tr_b16 a[88:89], v10 offset:41984
    ds_read_b64_tr_b16 a[90:91], v10 offset:42240
    v_mfma_f32_32x32x16_bf16 v[40:55], a[48:51], a[52:55], v[40:55]
    ds_read_b64_tr_b16 a[92:93], v10 offset:46080
    ds_read_b64_tr_b16 a[94:95], v10 offset:46336
    ds_read_b128 a[96:99], v7 offset:16384
    v_mfma_f32_32x32x16_bf16 v[56:71], a[48:51], a[56:59], v[56:71]
    ds_read_b64_tr_b16 a[100:101], v10 offset:38912
    ds_read_b64_tr_b16 a[102:103], v10 offset:39168
    ds_read_b64_tr_b16 a[104:105], v10 offset:43008
    v_mfma_f32_32x32x16_bf16 v[72:87], a[48:51], a[60:63], v[72:87]
    ds_read_b64_tr_b16 a[106:107], v10 offset:43264
    ds_read_b64_tr_b16 a[108:109], v10 offset:47104
    ds_read_b64_tr_b16 a[110:111], v10 offset:47360
    s_waitcnt lgkmcnt(14)
    v_mfma_f32_32x32x16_bf16 v[40:55], a[64:67], a[68:71], v[40:55]
    ds_read_b128 a[112:115], v8 offset:16384
    ds_read_b64_tr_b16 a[116:117], v10 offset:39936
    ds_read_b64_tr_b16 a[118:119], v10 offset:40192
    v_mfma_f32_32x32x16_bf16 v[56:71], a[64:67], a[72:75], v[56:71]
    ds_read_b64_tr_b16 a[120:121], v10 offset:44032
    ds_read_b64_tr_b16 a[122:123], v10 offset:44288
    v_mfma_f32_32x32x16_bf16 v[72:87], a[64:67], a[76:79], v[72:87]
    ds_read_b64_tr_b16 a[124:125], v10 offset:48128
    ds_read_b64_tr_b16 a[126:127], v10 offset:48384
    s_waitcnt lgkmcnt(14)
    v_mfma_f32_32x32x16_bf16 v[40:55], a[80:83], a[84:87], v[40:55]
    v_mfma_f32_32x32x16_bf16 v[56:71], a[80:83], a[88:91], v[56:71]
    v_mfma_f32_32x32x16_bf16 v[72:87], a[80:83], a[92:95], v[72:87]
    s_waitcnt lgkmcnt(0)
    s_barrier
    v_mfma_f32_32x32x16_bf16 v[40:55], a[96:99], a[100:103], v[40:55]
    ds_read_b128 a[0:3], v5 offset:32768
    ds_read_b64_tr_b16 a[4:5], v10 offset:12288
    ds_read_b64_tr_b16 a[6:7], v10 offset:12544
    ds_read_b64_tr_b16 a[8:9], v10 offset:16384
    v_mfma_f32_32x32x16_bf16 v[56:71], a[96:99], a[104:107], v[56:71]
    ds_read_b64_tr_b16 a[10:11], v10 offset:16640
    ds_read_b64_tr_b16 a[12:13], v10 offset:20480
    ds_read_b64_tr_b16 a[14:15], v10 offset:20736
    ds_read_b128 a[16:19], v6 offset:32768
    v_mfma_f32_32x32x16_bf16 v[72:87], a[96:99], a[108:111], v[72:87]
    ds_read_b64_tr_b16 a[20:21], v10 offset:13312
    ds_read_b64_tr_b16 a[22:23], v10 offset:13568
    ds_read_b64_tr_b16 a[24:25], v10 offset:17408
    ds_read_b64_tr_b16 a[26:27], v10 offset:17664
    v_mfma_f32_32x32x16_bf16 v[40:55], a[112:115], a[116:119], v[40:55]
    ds_read_b64_tr_b16 a[28:29], v10 offset:21504
    ds_read_b64_tr_b16 a[30:31], v10 offset:21760
    ds_read_b128 a[32:35], v7 offset:32768
    v_mfma_f32_32x32x16_bf16 v[56:71], a[112:115], a[120:123], v[56:71]
    ds_read_b64_tr_b16 a[36:37], v10 offset:14336
    ds_read_b64_tr_b16 a[38:39], v10 offset:14592
    ds_read_b64_tr_b16 a[40:41], v10 offset:18432
    v_mfma_f32_32x32x16_bf16 v[72:87], a[112:115], a[124:127], v[72:87]
    ds_read_b64_tr_b16 a[42:43], v10 offset:18688
    ds_read_b64_tr_b16 a[44:45], v10 offset:22528
    ds_read_b64_tr_b16 a[46:47], v10 offset:22784
    s_waitcnt lgkmcnt(14)
    v_mfma_f32_32x32x16_bf16 v[40:55], a[0:3], a[4:7], v[40:55]
    ds_read_b128 a[48:51], v8 offset:32768
    ds_read_b64_tr_b16 a[52:53], v10 offset:15360
    ds_read_b64_tr_b16 a[54:55], v10 offset:15616
    v_mfma_f32_32x32x16_bf16 v[56:71], a[0:3], a[8:11], v[56:71]
    ds_read_b64_tr_b16 a[56:57], v10 offset:19456
    ds_read_b64_tr_b16 a[58:59], v10 offset:19712
    v_mfma_f32_32x32x16_bf16 v[72:87], a[0:3], a[12:15], v[72:87]
    ds_read_b64_tr_b16 a[60:61], v10 offset:23552
    ds_read_b64_tr_b16 a[62:63], v10 offset:23808
    s_waitcnt lgkmcnt(14)
    v_mfma_f32_32x32x16_bf16 v[40:55], a[16:19], a[20:23], v[40:55]
    v_mfma_f32_32x32x16_bf16 v[56:71], a[16:19], a[24:27], v[56:71]
    v_mfma_f32_32x32x16_bf16 v[72:87], a[16:19], a[28:31], v[72:87]
    buffer_load_dwordx2 v[32:33], v3, s[48:51], 0 offen sc1
    s_waitcnt lgkmcnt(0)
    s_barrier
    v_mfma_f32_32x32x16_bf16 v[40:55], a[32:35], a[36:39], v[40:55]
    ds_read_b128 a[64:67], v5 offset:49152
    ds_read_b64_tr_b16 a[68:69], v10 offset:24576
    ds_read_b64_tr_b16 a[70:71], v10 offset:24832
    ds_read_b64_tr_b16 a[72:73], v10 offset:28672
    v_mfma_f32_32x32x16_bf16 v[56:71], a[32:35], a[40:43], v[56:71]
    ds_read_b64_tr_b16 a[74:75], v10 offset:28928
    ds_read_b64_tr_b16 a[76:77], v10 offset:32768
    ds_read_b64_tr_b16 a[78:79], v10 offset:33024
    ds_read_b128 a[80:83], v6 offset:49152
    v_mfma_f32_32x32x16_bf16 v[72:87], a[32:35], a[44:47], v[72:87]
    ds_read_b64_tr_b16 a[84:85], v10 offset:25600
    ds_read_b64_tr_b16 a[86:87], v10 offset:25856
    ds_read_b64_tr_b16 a[88:89], v10 offset:29696
    ds_read_b64_tr_b16 a[90:91], v10 offset:29952
    v_mfma_f32_32x32x16_bf16 v[40:55], a[48:51], a[52:55], v[40:55]
    ds_read_b64_tr_b16 a[92:93], v10 offset:33792
    ds_read_b64_tr_b16 a[94:95], v10 offset:34048
    ds_read_b128 a[96:99], v7 offset:49152
    v_mfma_f32_32x32x16_bf16 v[56:71], a[48:51], a[56:59], v[56:71]
    ds_read_b64_tr_b16 a[100:101], v10 offset:26624
    ds_read_b64_tr_b16 a[102:103], v10 offset:26880
    ds_read_b64_tr_b16 a[104:105], v10 offset:30720
    v_mfma_f32_32x32x16_bf16 v[72:87], a[48:51], a[60:63], v[72:87]
    ds_read_b64_tr_b16 a[106:107], v10 offset:30976
    ds_read_b64_tr_b16 a[108:109], v10 offset:34816
    ds_read_b64_tr_b16 a[110:111], v10 offset:35072
    s_waitcnt lgkmcnt(14)
    v_mfma_f32_32x32x16_bf16 v[40:55], a[64:67], a[68:71], v[40:55]
    ds_read_b128 a[112:115], v8 offset:49152
    ds_read_b64_tr_b16 a[116:117], v10 offset:27648
    ds_read_b64_tr_b16 a[118:119], v10 offset:27904
    v_mfma_f32_32x32x16_bf16 v[56:71], a[64:67], a[72:75], v[56:71]
    ds_read_b64_tr_b16 a[120:121], v10 offset:31744
    ds_read_b64_tr_b16 a[122:123], v10 offset:32000
    v_mfma_f32_32x32x16_bf16 v[72:87], a[64:67], a[76:79], v[72:87]
    ds_read_b64_tr_b16 a[124:125], v10 offset:35840
    ds_read_b64_tr_b16 a[126:127], v10 offset:36096
    s_waitcnt lgkmcnt(14)
    v_mfma_f32_32x32x16_bf16 v[40:55], a[80:83], a[84:87], v[40:55]
    v_mfma_f32_32x32x16_bf16 v[56:71], a[80:83], a[88:91], v[56:71]
    v_mfma_f32_32x32x16_bf16 v[72:87], a[80:83], a[92:95], v[72:87]
    s_waitcnt lgkmcnt(7)
    v_mfma_f32_32x32x16_bf16 v[40:55], a[96:99], a[100:103], v[40:55]
    v_mfma_f32_32x32x16_bf16 v[56:71], a[96:99], a[104:107], v[56:71]
    v_mfma_f32_32x32x16_bf16 v[72:87], a[96:99], a[108:111], v[72:87]
    s_waitcnt lgkmcnt(0)
    v_mfma_f32_32x32x16_bf16 v[40:55], a[112:115], a[116:119], v[40:55]
    v_mfma_f32_32x32x16_bf16 v[56:71], a[112:115], a[120:123], v[56:71]
    v_mfma_f32_32x32x16_bf16 v[72:87], a[112:115], a[124:127], v[72:87]
    s_nop 9
    v_cvt_pk_bf16_f32 v88, v40, v41
    v_cvt_pk_bf16_f32 v89, v42, v43
    v_cvt_pk_bf16_f32 v90, v44, v45
    v_cvt_pk_bf16_f32 v91, v46, v47
    v_cvt_pk_bf16_f32 v92, v48, v49
    v_cvt_pk_bf16_f32 v93, v50, v51
    v_cvt_pk_bf16_f32 v94, v52, v53
    v_cvt_pk_bf16_f32 v95, v54, v55
    buffer_store_dwordx4 v[88:91], v21, s[40:43], s75 offen offset:1024 sc1
    buffer_store_dwordx4 v[92:95], v21, s[40:43], s75 offen offset:1536 sc1
    v_cvt_pk_bf16_f32 v96, v56, v57
    v_cvt_pk_bf16_f32 v97, v58, v59
    v_cvt_pk_bf16_f32 v98, v60, v61
    v_cvt_pk_bf16_f32 v99, v62, v63
    v_cvt_pk_bf16_f32 v100, v64, v65
    v_cvt_pk_bf16_f32 v101, v66, v67
    v_cvt_pk_bf16_f32 v102, v68, v69
    v_cvt_pk_bf16_f32 v103, v70, v71
    buffer_store_dwordx4 v[96:99], v21, s[40:43], s76 offen offset:1024 sc1
    buffer_store_dwordx4 v[100:103], v21, s[40:43], s76 offen offset:1536 sc1
    v_cvt_pk_bf16_f32 v104, v72, v73
    v_cvt_pk_bf16_f32 v105, v74, v75
    v_cvt_pk_bf16_f32 v106, v76, v77
    v_cvt_pk_bf16_f32 v107, v78, v79
    v_cvt_pk_bf16_f32 v108, v80, v81
    v_cvt_pk_bf16_f32 v109, v82, v83
    v_cvt_pk_bf16_f32 v110, v84, v85
    v_cvt_pk_bf16_f32 v111, v86, v87
    buffer_store_dwordx4 v[104:107], v21, s[40:43], s77 offen offset:1024 sc1
    buffer_store_dwordx4 v[108:111], v21, s[40:43], s77 offen offset:1536 sc1
    s_branch A_post
A_NNV:
    s_barrier
    ds_read_b128 a[0:3], v5 offset:0
    ds_read_b64_tr_b16 a[4:5], v10 offset:12288
    ds_read_b64_tr_b16 a[6:7], v10 offset:12544
    ds_read_b64_tr_b16 a[8:9], v10 offset:16384
    ds_read_b64_tr_b16 a[10:11], v10 offset:16640
    ds_read_b64_tr_b16 a[12:13], v10 offset:20480
    ds_read_b64_tr_b16 a[14:15], v10 offset:20736
    ds_read_b128 a[16:19], v6 offset:0
    ds_read_b64_tr_b16 a[20:21], v10 offset:13312
    ds_read_b64_tr_b16 a[22:23], v10 offset:13568
    ds_read_b64_tr_b16 a[24:25], v10 offset:17408
    ds_read_b64_tr_b16 a[26:27], v10 offset:17664
    ds_read_b64_tr_b16 a[28:29], v10 offset:21504
    ds_read_b64_tr_b16 a[30:31], v10 offset:21760
    ds_read_b128 a[32:35], v7 offset:0
    ds_read_b64_tr_b16 a[36:37], v10 offset:14336
    ds_read_b64_tr_b16 a[38:39], v10 offset:14592
    ds_read_b64_tr_b16 a[40:41], v10 offset:18432
    ds_read_b64_tr_b16 a[42:43], v10 offset:18688
    ds_read_b64_tr_b16 a[44:45], v10 offset:22528
    ds_read_b64_tr_b16 a[46:47], v10 offset:22784
    s_waitcnt lgkmcnt(14)
    v_mfma_f32_32x32x16_bf16 v[40:55], a[4:7], a[0:3], 0
    ds_read_b128 a[48:51], v8 offset:0
    ds_read_b64_tr_b16 a[52:53], v10 offset:15360
    ds_read_b64_tr_b16 a[54:55], v10 offset:15616
    v_mfma_f32_32x32x16_bf16 v[56:71], a[8:11], a[0:3], 0
    ds_read_b64_tr_b16 a[56:57], v10 offset:19456
    ds_read_b64_tr_b16 a[58:59], v10 offset:19712
    v_mfma_f32_32x32x16_bf16 v[72:87], a[0:3], a[12:15], 0
    ds_read_b64_tr_b16 a[60:61], v10 offset:23552
    ds_read_b64_tr_b16 a[62:63], v10 offset:23808
    s_waitcnt lgkmcnt(14)
    v_mfma_f32_32x32x16_bf16 v[40:55], a[20:23], a[16:19], v[40:55]
    v_mfma_f32_32x32x16_bf16 v[56:71], a[24:27], a[16:19], v[56:71]
    v_mfma_f32_32x32x16_bf16 v[72:87], a[16:19], a[28:31], v[72:87]
    s_waitcnt vmcnt(0)
    s_waitcnt lgkmcnt(0)
    s_barrier
    v_mfma_f32_32x32x16_bf16 v[40:55], a[36:39], a[32:35], v[40:55]
    ds_read_b128 a[64:67], v5 offset:16384
    ds_read_b64_tr_b16 a[68:69], v10 offset:24576
    ds_read_b64_tr_b16 a[70:71], v10 offset:24832
    ds_read_b64_tr_b16 a[72:73], v10 offset:28672
    v_mfma_f32_32x32x16_bf16 v[56:71], a[40:43], a[32:35], v[56:71]
    ds_read_b64_tr_b16 a[74:75], v10 offset:28928
    ds_read_b64_tr_b16 a[76:77], v10 offset:32768
    ds_read_b64_tr_b16 a[78:79], v10 offset:33024
    ds_read_b128 a[80:83], v6 offset:16384
    v_mfma_f32_32x32x16_bf16 v[72:87], a[32:35], a[44:47], v[72:87]
    ds_read_b64_tr_b16 a[84:85], v10 offset:25600
    ds_read_b64_tr_b16 a[86:87], v10 offset:25856
    ds_read_b64_tr_b16 a[88:89], v10 offset:29696
    ds_read_b64_tr_b16 a[90:91], v10 offset:29952
    v_mfma_f32_32x32x16_bf16 v[40:55], a[52:55], a[48:51], v[40:55]
    ds_read_b64_tr_b16 a[92:93], v10 offset:33792
    ds_read_b64_tr_b16 a[94:95], v10 offset:34048
    ds_read_b128 a[96:99], v7 offset:16384
    v_mfma_f32_32x32x16_bf16 v[56:71], a[56:59], a[48:51], v[56:71]
    ds_read_b64_tr_b16 a[100:101], v10 offset:26624
    ds_read_b64_tr_b16 a[102:103], v10 offset:26880
    ds_read_b64_tr_b16 a[104:105], v10 offset:30720
    v_mfma_f32_32x32x16_bf16 v[72:87], a[48:51], a[60:63], v[72:87]
    ds_read_b64_tr_b16 a[106:107], v10 offset:30976
    ds_read_b64_tr_b16 a[108:109], v10 offset:34816
    ds_read_b64_tr_b16 a[110:111], v10 offset:35072
    s_waitcnt lgkmcnt(14)
    v_mfma_f32_32x32x16_bf16 v[40:55], a[68:71], a[64:67], v[40:55]
    ds_read_b128 a[112:115], v8 offset:16384
    ds_read_b64_tr_b16 a[116:117], v10 offset:27648
    ds_read_b64_tr_b16 a[118:119], v10 offset:27904
    v_mfma_f32_32x32x16_bf16 v[56:71], a[72:75], a[64:67], v[56:71]
    ds_read_b64_tr_b16 a[120:121], v10 offset:31744
    ds_read_b64_tr_b16 a[122:123], v10 offset:32000
    v_mfma_f32_32x32x16_bf16 v[72:87], a[64:67], a[76:79], v[72:87]
    ds_read_b64_tr_b16 a[124:125], v10 offset:35840
    ds_read_b64_tr_b16 a[126:127], v10 offset:36096
    s_waitcnt lgkmcnt(14)
    v_mfma_f32_32x32x16_bf16 v[40:55], a[84:87], a[80:83], v[40:55]
    v_mfma_f32_32x32x16_bf16 v[56:71], a[88:91], a[80:83], v[56:71]
    v_mfma_f32_32x32x16_bf16 v[72:87], a[80:83], a[92:95], v[72:87]
    s_waitcnt lgkmcnt(0)
    s_barrier
    v_mfma_f32_32x32x16_bf16 v[40:55], a[100:103], a[96:99], v[40:55]
    ds_read_b128 a[0:3], v5 offset:32768
    ds_read_b64_tr_b16 a[4:5], v10 offset:36864
    ds_read_b64_tr_b16 a[6:7], v10 offset:37120
    ds_read_b64_tr_b16 a[8:9], v10 offset:40960
    v_mfma_f32_32x32x16_bf16 v[56:71], a[104:107], a[96:99], v[56:71]
    ds_read_b64_tr_b16 a[10:11], v10 offset:41216
    ds_read_b64_tr_b16 a[12:13], v10 offset:45056
    ds_read_b64_tr_b16 a[14:15], v10 offset:45312
    ds_read_b128 a[16:19], v6 offset:32768
    v_mfma_f32_32x32x16_bf16 v[72:87], a[96:99], a[108:111], v[72:87]
    ds_read_b64_tr_b16 a[20:21], v10 offset:37888
    ds_read_b64_tr_b16 a[22:23], v10 offset:38144
    ds_read_b64_tr_b16 a[24:25], v10 offset:41984
    ds_read_b64_tr_b16 a[26:27], v10 offset:42240
    v_mfma_f32_32x32x16_bf16 v[40:55], a[116:119], a[112:115], v[40:55]
    ds_read_b64_tr_b16 a[28:29], v10 offset:46080
    ds_read_b64_tr_b16 a[30:31], v10 offset:46336
    ds_read_b128 a[32:35], v7 offset:32768
    v_mfma_f32_32x32x16_bf16 v[56:71], a[120:123], a[112:115], v[56:71]
    ds_read_b64_tr_b16 a[36:37], v10 offset:38912
    ds_read_b64_tr_b16 a[38:39], v10 offset:39168
    ds_read_b64_tr_b16 a[40:41], v10 offset:43008
    v_mfma_f32_32x32x16_bf16 v[72:87], a[112:115], a[124:127], v[72:87]
    ds_read_b64_tr_b16 a[42:43], v10 offset:43264
    ds_read_b64_tr_b16 a[44:45], v10 offset:47104
    ds_read_b64_tr_b16 a[46:47], v10 offset:47360
    s_waitcnt lgkmcnt(14)
    v_mfma_f32_32x32x16_bf16 v[40:55], a[4:7], a[0:3], v[40:55]
    ds_read_b128 a[48:51], v8 offset:32768
    ds_read_b64_tr_b16 a[52:53], v10 offset:39936
    ds_read_b64_tr_b16 a[54:55], v10 offset:40192
    v_mfma_f32_32x32x16_bf16 v[56:71], a[8:11], a[0:3], v[56:71]
    ds_read_b64_tr_b16 a[56:57], v10 offset:44032
    ds_read_b64_tr_b16 a[58:59], v10 offset:44288
    v_mfma_f32_32x32x16_bf16 v[72:87], a[0:3], a[12:15], v[72:87]
    ds_read_b64_tr_b16 a[60:61], v10 offset:48128
    ds_read_b64_tr_b16 a[62:63], v10 offset:48384
    s_waitcnt lgkmcnt(14)
    v_mfma_f32_32x32x16_bf16 v[40:55], a[20:23], a[16:19], v[40:55]
    v_mfma_f32_32x32x16_bf16 v[56:71], a[24:27], a[16:19], v[56:71]
    v_mfma_f32_32x32x16_bf16 v[72:87], a[16:19], a[28:31], v[72:87]
    s_waitcnt lgkmcnt(0)
    s_barrier
    v_mfma_f32_32x32x16_bf16 v[40:55], a[36:39], a[32:35], v[40:55]
    ds_read_b128 a[64:67], v5 offset:49152
    ds_read_b64_tr_b16 a[68:69], v10 offset:12288
    ds_read_b64_tr_b16 a[70:71], v10 offset:12544
    ds_read_b64_tr_b16 a[72:73], v10 offset:16384
    v_mfma_f32_32x32x16_bf16 v[56:71], a[40:43], a[32:35], v[56:71]
    ds_read_b64_tr_b16 a[74:75], v10 offset:16640
    ds_read_b64_tr_b16 a[76:77], v10 offset:20480
    ds_read_b64_tr_b16 a[78:79], v10 offset:20736
    ds_read_b128 a[80:83], v6 offset:49152
    v_mfma_f32_32x32x16_bf16 v[72:87], a[32:35], a[44:47], v[72:87]
    ds_read_b64_tr_b16 a[84:85], v10 offset:13312
    ds_read_b64_tr_b16 a[86:87], v10 offset:13568
    ds_read_b64_tr_b16 a[88:89], v10 offset:17408
    ds_read_b64_tr_b16 a[90:91], v10 offset:17664
    v_mfma_f32_32x32x16_bf16 v[40:55], a[52:55], a[48:51], v[40:55]
    ds_read_b64_tr_b16 a[92:93], v10 offset:21504
    ds_read_b64_tr_b16 a[94:95], v10 offset:21760
    ds_read_b128 a[96:99], v7 offset:49152
    v_mfma_f32_32x32x16_bf16 v[56:71], a[56:59], a[48:51], v[56:71]
    ds_read_b64_tr_b16 a[100:101], v10 offset:14336
    ds_read_b64_tr_b16 a[102:103], v10 offset:14592
    ds_read_b64_tr_b16 a[104:105], v10 offset:18432
    v_mfma_f32_32x32x16_bf16 v[72:87], a[48:51], a[60:63], v[72:87]
    ds_read_b64_tr_b16 a[106:107], v10 offset:18688
    ds_read_b64_tr_b16 a[108:109], v10 offset:22528
    ds_read_b64_tr_b16 a[110:111], v10 offset:22784
    s_waitcnt lgkmcnt(14)
    v_mfma_f32_32x32x16_bf16 v[40:55], a[68:71], a[64:67], v[40:55]
    ds_read_b128 a[112:115], v8 offset:49152
    ds_read_b64_tr_b16 a[116:117], v10 offset:15360
    ds_read_b64_tr_b16 a[118:119], v10 offset:15616
    v_mfma_f32_32x32x16_bf16 v[56:71], a[72:75], a[64:67], v[56:71]
    ds_read_b64_tr_b16 a[120:121], v10 offset:19456
    ds_read_b64_tr_b16 a[122:123], v10 offset:19712
    v_mfma_f32_32x32x16_bf16 v[72:87], a[64:67], a[76:79], v[72:87]
    ds_read_b64_tr_b16 a[124:125], v10 offset:23552
    ds_read_b64_tr_b16 a[126:127], v10 offset:23808
    s_waitcnt lgkmcnt(14)
    v_mfma_f32_32x32x16_bf16 v[40:55], a[84:87], a[80:83], v[40:55]
    v_mfma_f32_32x32x16_bf16 v[56:71], a[88:91], a[80:83], v[56:71]
    v_mfma_f32_32x32x16_bf16 v[72:87], a[80:83], a[92:95], v[72:87]
    s_waitcnt lgkmcnt(0)
    s_barrier
    v_mfma_f32_32x32x16_bf16 v[40:55], a[100:103], a[96:99], v[40:55]
    ds_read_b128 a[0:3], v5 offset:0
    ds_read_b64_tr_b16 a[4:5], v10 offset:24576
    ds_read_b64_tr_b16 a[6:7], v10 offset:24832
    ds_read_b64_tr_b16 a[8:9], v10 offset:28672
    v_mfma_f32_32x32x16_bf16 v[56:71], a[104:107], a[96:99], v[56:71]
    ds_read_b64_tr_b16 a[10:11], v10 offset:28928
    ds_read_b64_tr_b16 a[12:13], v10 offset:32768
    ds_read_b64_tr_b16 a[14:15], v10 offset:33024
    ds_read_b128 a[16:19], v6 offset:0
    v_mfma_f32_32x32x16_bf16 v[72:87], a[96:99], a[108:111], v[72:87]
    ds_read_b64_tr_b16 a[20:21], v10 offset:25600
    ds_read_b64_tr_b16 a[22:23], v10 offset:25856
    ds_read_b64_tr_b16 a[24:25], v10 offset:29696
    ds_read_b64_tr_b16 a[26:27], v10 offset:29952
    v_mfma_f32_32x32x16_bf16 v[40:55], a[116:119], a[112:115], v[40:55]
    ds_read_b64_tr_b16 a[28:29], v10 offset:33792
    ds_read_b64_tr_b16 a[30:31], v10 offset:34048
    ds_read_b128 a[32:35], v7 offset:0
    v_mfma_f32_32x32x16_bf16 v[56:71], a[120:123], a[112:115], v[56:71]
    ds_read_b64_tr_b16 a[36:37], v10 offset:26624
    ds_read_b64_tr_b16 a[38:39], v10 offset:26880
    ds_read_b64_tr_b16 a[40:41], v10 offset:30720
    v_mfma_f32_32x32x16_bf16 v[72:87], a[112:115], a[124:127], v[72:87]
    ds_read_b64_tr_b16 a[42:43], v10 offset:30976
    ds_read_b64_tr_b16 a[44:45], v10 offset:34816
    ds_read_b64_tr_b16 a[46:47], v10 offset:35072
    s_waitcnt lgkmcnt(14)
    v_mfma_f32_32x32x16_bf16 v[40:55], a[4:7], a[0:3], v[40:55]
    ds_read_b128 a[48:51], v8 offset:0
    ds_read_b64_tr_b16 a[52:53], v10 offset:27648
    ds_read_b64_tr_b16 a[54:55], v10 offset:27904
    v_mfma_f32_32x32x16_bf16 v[56:71], a[8:11], a[0:3], v[56:71]
    ds_read_b64_tr_b16 a[56:57], v10 offset:31744
    ds_read_b64_tr_b16 a[58:59], v10 offset:32000
    v_mfma_f32_32x32x16_bf16 v[72:87], a[0:3], a[12:15], v[72:87]
    ds_read_b64_tr_b16 a[60:61], v10 offset:35840
    ds_read_b64_tr_b16 a[62:63], v10 offset:36096
    s_waitcnt lgkmcnt(14)
    v_mfma_f32_32x32x16_bf16 v[40:55], a[20:23], a[16:19], v[40:55]
    v_mfma_f32_32x32x16_bf16 v[56:71], a[24:27], a[16:19], v[56:71]
    v_mfma_f32_32x32x16_bf16 v[72:87], a[16:19], a[28:31], v[72:87]
    s_waitcnt lgkmcnt(0)
    s_barrier
    v_mfma_f32_32x32x16_bf16 v[40:55], a[36:39], a[32:35], v[40:55]
    ds_read_b128 a[64:67], v5 offset:16384
    ds_read_b64_tr_b16 a[68:69], v10 offset:36864
    ds_read_b64_tr_b16 a[70:71], v10 offset:37120
    ds_read_b64_tr_b16 a[72:73], v10 offset:40960
    v_mfma_f32_32x32x16_bf16 v[56:71], a[40:43], a[32:35], v[56:71]
    ds_read_b64_tr_b16 a[74:75], v10 offset:41216
    ds_read_b64_tr_b16 a[76:77], v10 offset:45056
    ds_read_b64_tr_b16 a[78:79], v10 offset:45312
    ds_read_b128 a[80:83], v6 offset:16384
    v_mfma_f32_32x32x16_bf16 v[72:87], a[32:35], a[44:47], v[72:87]
    ds_read_b64_tr_b16 a[84:85], v10 offset:37888
    ds_read_b64_tr_b16 a[86:87], v10 offset:38144
    ds_read_b64_tr_b16 a[88:89], v10 offset:41984
    ds_read_b64_tr_b16 a[90:91], v10 offset:42240
    v_mfma_f32_32x32x16_bf16 v[40:55], a[52:55], a[48:51], v[40:55]
    ds_read_b64_tr_b16 a[92:93], v10 offset:46080
    ds_read_b64_tr_b16 a[94:95], v10 offset:46336
    ds_read_b128 a[96:99], v7 offset:16384
    v_mfma_f32_32x32x16_bf16 v[56:71], a[56:59], a[48:51], v[56:71]
    ds_read_b64_tr_b16 a[100:101], v10 offset:38912
    ds_read_b64_tr_b16 a[102:103], v10 offset:39168
    ds_read_b64_tr_b16 a[104:105], v10 offset:43008
    v_mfma_f32_32x32x16_bf16 v[72:87], a[48:51], a[60:63], v[72:87]
    ds_read_b64_tr_b16 a[106:107], v10 offset:43264
    ds_read_b64_tr_b16 a[108:109], v10 offset:47104
    ds_read_b64_tr_b16 a[110:111], v10 offset:47360
    s_waitcnt lgkmcnt(14)
    v_mfma_f32_32x32x16_bf16 v[40:55], a[68:71], a[64:67], v[40:55]
    ds_read_b128 a[112:115], v8 offset:16384
    ds_read_b64_tr_b16 a[116:117], v10 offset:39936
    ds_read_b64_tr_b16 a[118:119], v10 offset:40192
    v_mfma_f32_32x32x16_bf16 v[56:71], a[72:75], a[64:67], v[56:71]
    ds_read_b64_tr_b16 a[120:121], v10 offset:44032
    ds_read_b64_tr_b16 a[122:123], v10 offset:44288
    v_mfma_f32_32x32x16_bf16 v[72:87], a[64:67], a[76:79], v[72:87]
    ds_read_b64_tr_b16 a[124:125], v10 offset:48128
    ds_read_b64_tr_b16 a[126:127], v10 offset:48384
    s_waitcnt lgkmcnt(14)
    v_mfma_f32_32x32x16_bf16 v[40:55], a[84:87], a[80:83], v[40:55]
    v_mfma_f32_32x32x16_bf16 v[56:71], a[88:91], a[80:83], v[56:71]
    v_mfma_f32_32x32x16_bf16 v[72:87], a[80:83], a[92:95], v[72:87]
    s_waitcnt lgkmcnt(0)
    s_barrier
    v_mfma_f32_32x32x16_bf16 v[40:55], a[100:103], a[96:99], v[40:55]
    ds_read_b128 a[0:3], v5 offset:32768
    ds_read_b64_tr_b16 a[4:5], v10 offset:12288
    ds_read_b64_tr_b16 a[6:7], v10 offset:12544
    ds_read_b64_tr_b16 a[8:9], v10 offset:16384
    v_mfma_f32_32x32x16_bf16 v[56:71], a[104:107], a[96:99], v[56:71]
    ds_read_b64_tr_b16 a[10:11], v10 offset:16640
    ds_read_b64_tr_b16 a[12:13], v10 offset:20480
    ds_read_b64_tr_b16 a[14:15], v10 offset:20736
    ds_read_b128 a[16:19], v6 offset:32768
    v_mfma_f32_32x32x16_bf16 v[72:87], a[96:99], a[108:111], v[72:87]
    ds_read_b64_tr_b16 a[20:21], v10 offset:13312
    ds_read_b64_tr_b16 a[22:23], v10 offset:13568
    ds_read_b64_tr_b16 a[24:25], v10 offset:17408
    ds_read_b64_tr_b16 a[26:27], v10 offset:17664
    v_mfma_f32_32x32x16_bf16 v[40:55], a[116:119], a[112:115], v[40:55]
    ds_read_b64_tr_b16 a[28:29], v10 offset:21504
    ds_read_b64_tr_b16 a[30:31], v10 offset:21760
    ds_read_b128 a[32:35], v7 offset:32768
    v_mfma_f32_32x32x16_bf16 v[56:71], a[120:123], a[112:115], v[56:71]
    ds_read_b64_tr_b16 a[36:37], v10 offset:14336
    ds_read_b64_tr_b16 a[38:39], v10 offset:14592
    ds_read_b64_tr_b16 a[40:41], v10 offset:18432
    v_mfma_f32_32x32x16_bf16 v[72:87], a[112:115], a[124:127], v[72:87]
    ds_read_b64_tr_b16 a[42:43], v10 offset:18688
    ds_read_b64_tr_b16 a[44:45], v10 offset:22528
    ds_read_b64_tr_b16 a[46:47], v10 offset:22784
    s_waitcnt lgkmcnt(14)
    v_mfma_f32_32x32x16_bf16 v[40:55], a[4:7], a[0:3], v[40:55]
    ds_read_b128 a[48:51], v8 offset:32768
    ds_read_b64_tr_b16 a[52:53], v10 offset:15360
    ds_read_b64_tr_b16 a[54:55], v10 offset:15616
    v_mfma_f32_32x32x16_bf16 v[56:71], a[8:11], a[0:3], v[56:71]
    ds_read_b64_tr_b16 a[56:57], v10 offset:19456
    ds_read_b64_tr_b16 a[58:59], v10 offset:19712
    v_mfma_f32_32x32x16_bf16 v[72:87], a[0:3], a[12:15], v[72:87]
    ds_read_b64_tr_b16 a[60:61], v10 offset:23552
    ds_read_b64_tr_b16 a[62:63], v10 offset:23808
    s_waitcnt lgkmcnt(14)
    v_mfma_f32_32x32x16_bf16 v[40:55], a[20:23], a[16:19], v[40:55]
    v_mfma_f32_32x32x16_bf16 v[56:71], a[24:27], a[16:19], v[56:71]
    v_mfma_f32_32x32x16_bf16 v[72:87], a[16:19], a[28:31], v[72:87]
    buffer_load_dwordx2 v[32:33], v3, s[48:51], 0 offen sc1
    s_waitcnt lgkmcnt(0)
    s_barrier
    v_mfma_f32_32x32x16_bf16 v[40:55], a[36:39], a[32:35], v[40:55]
    ds_read_b128 a[64:67], v5 offset:49152
    ds_read_b64_tr_b16 a[68:69], v10 offset:24576
    ds_read_b64_tr_b16 a[70:71], v10 offset:24832
    ds_read_b64_tr_b16 a[72:73], v10 offset:28672
    v_mfma_f32_32x32x16_bf16 v[56:71], a[40:43], a[32:35], v[56:71]
    ds_read_b64_tr_b16 a[74:75], v10 offset:28928
    ds_read_b64_tr_b16 a[76:77], v10 offset:32768
    ds_read_b64_tr_b16 a[78:79], v10 offset:33024
    ds_read_b128 a[80:83], v6 offset:49152
    v_mfma_f32_32x32x16_bf16 v[72:87], a[32:35], a[44:47], v[72:87]
    ds_read_b64_tr_b16 a[84:85], v10 offset:25600
    ds_read_b64_tr_b16 a[86:87], v10 offset:25856
    ds_read_b64_tr_b16 a[88:89], v10 offset:29696
    ds_read_b64_tr_b16 a[90:91], v10 offset:29952
    v_mfma_f32_32x32x16_bf16 v[40:55], a[52:55], a[48:51], v[40:55]
    ds_read_b64_tr_b16 a[92:93], v10 offset:33792
    ds_read_b64_tr_b16 a[94:95], v10 offset:34048
    ds_read_b128 a[96:99], v7 offset:49152
    v_mfma_f32_32x32x16_bf16 v[56:71], a[56:59], a[48:51], v[56:71]
    ds_read_b64_tr_b16 a[100:101], v10 offset:26624
    ds_read_b64_tr_b16 a[102:103], v10 offset:26880
    ds_read_b64_tr_b16 a[104:105], v10 offset:30720
    v_mfma_f32_32x32x16_bf16 v[72:87], a[48:51], a[60:63], v[72:87]
    ds_read_b64_tr_b16 a[106:107], v10 offset:30976
    ds_read_b64_tr_b16 a[108:109], v10 offset:34816
    ds_read_b64_tr_b16 a[110:111], v10 offset:35072
    s_waitcnt lgkmcnt(14)
    v_mfma_f32_32x32x16_bf16 v[40:55], a[68:71], a[64:67], v[40:55]
    ds_read_b128 a[112:115], v8 offset:49152
    ds_read_b64_tr_b16 a[116:117], v10 offset:27648
    ds_read_b64_tr_b16 a[118:119], v10 offset:27904
    v_mfma_f32_32x32x16_bf16 v[56:71], a[72:75], a[64:67], v[56:71]
    ds_read_b64_tr_b16 a[120:121], v10 offset:31744
    ds_read_b64_tr_b16 a[122:123], v10 offset:32000
    v_mfma_f32_32x32x16_bf16 v[72:87], a[64:67], a[76:79], v[72:87]
    ds_read_b64_tr_b16 a[124:125], v10 offset:35840
    ds_read_b64_tr_b16 a[126:127], v10 offset:36096
    s_waitcnt lgkmcnt(14)
    v_mfma_f32_32x32x16_bf16 v[40:55], a[84:87], a[80:83], v[40:55]
    v_mfma_f32_32x32x16_bf16 v[56:71], a[88:91], a[80:83], v[56:71]
    v_mfma_f32_32x32x16_bf16 v[72:87], a[80:83], a[92:95], v[72:87]
    s_waitcnt lgkmcnt(7)
    v_mfma_f32_32x32x16_bf16 v[40:55], a[100:103], a[96:99], v[40:55]
    v_mfma_f32_32x32x16_bf16 v[56:71], a[104:107], a[96:99], v[56:71]
    v_mfma_f32_32x32x16_bf16 v[72:87], a[96:99], a[108:111], v[72:87]
    s_waitcnt lgkmcnt(0)
    v_mfma_f32_32x32x16_bf16 v[40:55], a[116:119], a[112:115], v[40:55]
    v_mfma_f32_32x32x16_bf16 v[56:71], a[120:123], a[112:115], v[56:71]
    v_mfma_f32_32x32x16_bf16 v[72:87], a[112:115], a[124:127], v[72:87]
    s_nop 9
    v_mul_f32 v40, s72, v40
    v_mul_f32 v41, s72, v41
    v_mul_f32 v42, s72, v42
    v_mul_f32 v43, s72, v43
    v_mul_f32 v44, s72, v44
    v_mul_f32 v45, s72, v45
    v_mul_f32 v46, s72, v46
    v_mul_f32 v47, s72, v47
    v_mul_f32 v48, s72, v48
    v_mul_f32 v49, s72, v49
    v_mul_f32 v50, s72, v50
    v_mul_f32 v51, s72, v51
    v_mul_f32 v52, s72, v52
    v_mul_f32 v53, s72, v53
    v_mul_f32 v54, s72, v54
    v_mul_f32 v55, s72, v55
    v_cvt_pk_bf16_f32 v88, v40, v41
    v_cvt_pk_bf16_f32 v89, v42, v43
    v_cvt_pk_bf16_f32 v90, v44, v45
    v_cvt_pk_bf16_f32 v91, v46, v47
    v_cvt_pk_bf16_f32 v92, v48, v49
    v_cvt_pk_bf16_f32 v93, v50, v51
    v_cvt_pk_bf16_f32 v94, v52, v53
    v_cvt_pk_bf16_f32 v95, v54, v55
    buffer_store_dwordx4 v[88:91], v20, s[40:43], s75 offen sc1
    buffer_store_dwordx4 v[92:95], v20, s[40:43], s78 offen sc1
    v_mul_f32 v56, s73, v56
    v_mul_f32 v57, s73, v57
    v_mul_f32 v58, s73, v58
    v_mul_f32 v59, s73, v59
    v_mul_f32 v60, s73, v60
    v_mul_f32 v61, s73, v61
    v_mul_f32 v62, s73, v62
    v_mul_f32 v63, s73, v63
    v_mul_f32 v64, s73, v64
    v_mul_f32 v65, s73, v65
    v_mul_f32 v66, s73, v66
    v_mul_f32 v67, s73, v67
    v_mul_f32 v68, s73, v68
    v_mul_f32 v69, s73, v69
    v_mul_f32 v70, s73, v70
    v_mul_f32 v71, s73, v71
    v_cvt_pk_bf16_f32 v96, v56, v57
    v_cvt_pk_bf16_f32 v97, v58, v59
    v_cvt_pk_bf16_f32 v98, v60, v61
    v_cvt_pk_bf16_f32 v99, v62, v63
    v_cvt_pk_bf16_f32 v100, v64, v65
    v_cvt_pk_bf16_f32 v101, v66, v67
    v_cvt_pk_bf16_f32 v102, v68, v69
    v_cvt_pk_bf16_f32 v103, v70, v71
    buffer_store_dwordx4 v[96:99], v20, s[40:43], s76 offen sc1
    buffer_store_dwordx4 v[100:103], v20, s[40:43], s79 offen sc1
    v_cvt_pk_bf16_f32 v104, v72, v73
    v_cvt_pk_bf16_f32 v105, v74, v75
    v_cvt_pk_bf16_f32 v106, v76, v77
    v_cvt_pk_bf16_f32 v107, v78, v79
    v_cvt_pk_bf16_f32 v108, v80, v81
    v_cvt_pk_bf16_f32 v109, v82, v83
    v_cvt_pk_bf16_f32 v110, v84, v85
    v_cvt_pk_bf16_f32 v111, v86, v87
    buffer_store_dwordx4 v[104:107], v21, s[40:43], s77 offen offset:1024 sc1
    buffer_store_dwordx4 v[108:111], v21, s[40:43], s77 offen offset:1536 sc1
    s_branch A_post
A_NNN:
    s_barrier
    ds_read_b128 a[0:3], v5 offset:0
    ds_read_b64_tr_b16 a[4:5], v10 offset:12288
    ds_read_b64_tr_b16 a[6:7], v10 offset:12544
    ds_read_b64_tr_b16 a[8:9], v10 offset:16384
    ds_read_b64_tr_b16 a[10:11], v10 offset:16640
    ds_read_b64_tr_b16 a[12:13], v10 offset:20480
    ds_read_b64_tr_b16 a[14:15], v10 offset:20736
    ds_read_b128 a[16:19], v6 offset:0
    ds_read_b64_tr_b16 a[20:21], v10 offset:13312
    ds_read_b64_tr_b16 a[22:23], v10 offset:13568
    ds_read_b64_tr_b16 a[24:25], v10 offset:17408
    ds_read_b64_tr_b16 a[26:27], v10 offset:17664
    ds_read_b64_tr_b16 a[28:29], v10 offset:21504
    ds_read_b64_tr_b16 a[30:31], v10 offset:21760
    ds_read_b128 a[32:35], v7 offset:0
    ds_read_b64_tr_b16 a[36:37], v10 offset:14336
    ds_read_b64_tr_b16 a[38:39], v10 offset:14592
    ds_read_b64_tr_b16 a[40:41], v10 offset:18432
    ds_read_b64_tr_b16 a[42:43], v10 offset:18688
    ds_read_b64_tr_b16 a[44:45], v10 offset:22528
    ds_read_b64_tr_b16 a[46:47], v10 offset:22784
    s_waitcnt lgkmcnt(14)
    v_mfma_f32_32x32x16_bf16 v[40:55], a[4:7], a[0:3], 0
    ds_read_b128 a[48:51], v8 offset:0
    ds_read_b64_tr_b16 a[52:53], v10 offset:15360
    ds_read_b64_tr_b16 a[54:55], v10 offset:15616
    v_mfma_f32_32x32x16_bf16 v[56:71], a[8:11], a[0:3], 0
    ds_read_b64_tr_b16 a[56:57], v10 offset:19456
    ds_read_b64_tr_b16 a[58:59], v10 offset:19712
    v_mfma_f32_32x32x16_bf16 v[72:87], a[12:15], a[0:3], 0
    ds_read_b64_tr_b16 a[60:61], v10 offset:23552
    ds_read_b64_tr_b16 a[62:63], v10 offset:23808
    s_waitcnt lgkmcnt(14)
    v_mfma_f32_32x32x16_bf16 v[40:55], a[20:23], a[16:19], v[40:55]
    v_mfma_f32_32x32x16_bf16 v[56:71], a[24:27], a[16:19], v[56:71]
    v_mfma_f32_32x32x16_bf16 v[72:87], a[28:31], a[16:19], v[72:87]
    s_waitcnt vmcnt(0)
    s_waitcnt lgkmcnt(0)
    s_barrier
    v_mfma_f32_32x32x16_bf16 v[40:55], a[36:39], a[32:35], v[40:55]
    ds_read_b128 a[64:67], v5 offset:16384
    ds_read_b64_tr_b16 a[68:69], v10 offset:24576
    ds_read_b64_tr_b16 a[70:71], v10 offset:24832
    ds_read_b64_tr_b16 a[72:73], v10 offset:28672
    v_mfma_f32_32x32x16_bf16 v[56:71], a[40:43], a[32:35], v[56:71]
    ds_read_b64_tr_b16 a[74:75], v10 offset:28928
    ds_read_b64_tr_b16 a[76:77], v10 offset:32768
    ds_read_b64_tr_b16 a[78:79], v10 offset:33024
    ds_read_b128 a[80:83], v6 offset:16384
    v_mfma_f32_32x32x16_bf16 v[72:87], a[44:47], a[32:35], v[72:87]
    ds_read_b64_tr_b16 a[84:85], v10 offset:25600
    ds_read_b64_tr_b16 a[86:87], v10 offset:25856
    ds_read_b64_tr_b16 a[88:89], v10 offset:29696
    ds_read_b64_tr_b16 a[90:91], v10 offset:29952
    v_mfma_f32_32x32x16_bf16 v[40:55], a[52:55], a[48:51], v[40:55]
    ds_read_b64_tr_b16 a[92:93], v10 offset:33792
    ds_read_b64_tr_b16 a[94:95], v10 offset:34048
    ds_read_b128 a[96:99], v7 offset:16384
    v_mfma_f32_32x32x16_bf16 v[56:71], a[56:59], a[48:51], v[56:71]
    ds_read_b64_tr_b16 a[100:101], v10 offset:26624
    ds_read_b64_tr_b16 a[102:103], v10 offset:26880
    ds_read_b64_tr_b16 a[104:105], v10 offset:30720
    v_mfma_f32_32x32x16_bf16 v[72:87], a[60:63], a[48:51], v[72:87]
    ds_read_b64_tr_b16 a[106:107], v10 offset:30976
    ds_read_b64_tr_b16 a[108:109], v10 offset:34816
    ds_read_b64_tr_b16 a[110:111], v10 offset:35072
    s_waitcnt lgkmcnt(14)
    v_mfma_f32_32x32x16_bf16 v[40:55], a[68:71], a[64:67], v[40:55]
    ds_read_b128 a[112:115], v8 offset:16384
    ds_read_b64_tr_b16 a[116:117], v10 offset:27648
    ds_read_b64_tr_b16 a[118:119], v10 offset:27904
    v_mfma_f32_32x32x16_bf16 v[56:71], a[72:75], a[64:67], v[56:71]
    ds_read_b64_tr_b16 a[120:121], v10 offset:31744
    ds_read_b64_tr_b16 a[122:123], v10 offset:32000
    v_mfma_f32_32x32x16_bf16 v[72:87], a[76:79], a[64:67], v[72:87]
    ds_read_b64_tr_b16 a[124:125], v10 offset:35840
    ds_read_b64_tr_b16 a[126:127], v10 offset:36096
    s_waitcnt lgkmcnt(14)
    v_mfma_f32_32x32x16_bf16 v[40:55], a[84:87], a[80:83], v[40:55]
    v_mfma_f32_32x32x16_bf16 v[56:71], a[88:91], a[80:83], v[56:71]
    v_mfma_f32_32x32x16_bf16 v[72:87], a[92:95], a[80:83], v[72:87]
    s_waitcnt lgkmcnt(0)
    s_barrier
    v_mfma_f32_32x32x16_bf16 v[40:55], a[100:103], a[96:99], v[40:55]
    ds_read_b128 a[0:3], v5 offset:32768
    ds_read_b64_tr_b16 a[4:5], v10 offset:36864
    ds_read_b64_tr_b16 a[6:7], v10 offset:37120
    ds_read_b64_tr_b16 a[8:9], v10 offset:40960
    v_mfma_f32_32x32x16_bf16 v[56:71], a[104:107], a[96:99], v[56:71]
    ds_read_b64_tr_b16 a[10:11], v10 offset:41216
    ds_read_b64_tr_b16 a[12:13], v10 offset:45056
    ds_read_b64_tr_b16 a[14:15], v10 offset:45312
    ds_read_b128 a[16:19], v6 offset:32768
    v_mfma_f32_32x32x16_bf16 v[72:87], a[108:111], a[96:99], v[72:87]
    ds_read_b64_tr_b16 a[20:21], v10 offset:37888
    ds_read_b64_tr_b16 a[22:23], v10 offset:38144
    ds_read_b64_tr_b16 a[24:25], v10 offset:41984
    ds_read_b64_tr_b16 a[26:27], v10 offset:42240
    v_mfma_f32_32x32x16_bf16 v[40:55], a[116:119], a[112:115], v[40:55]
    ds_read_b64_tr_b16 a[28:29], v10 offset:46080
    ds_read_b64_tr_b16 a[30:31], v10 offset:46336
    ds_read_b128 a[32:35], v7 offset:32768
    v_mfma_f32_32x32x16_bf16 v[56:71], a[120:123], a[112:115], v[56:71]
    ds_read_b64_tr_b16 a[36:37], v10 offset:38912
    ds_read_b64_tr_b16 a[38:39], v10 offset:39168
    ds_read_b64_tr_b16 a[40:41], v10 offset:43008
    v_mfma_f32_32x32x16_bf16 v[72:87], a[124:127], a[112:115], v[72:87]
    ds_read_b64_tr_b16 a[42:43], v10 offset:43264
    ds_read_b64_tr_b16 a[44:45], v10 offset:47104
    ds_read_b64_tr_b16 a[46:47], v10 offset:47360
    s_waitcnt lgkmcnt(14)
    v_mfma_f32_32x32x16_bf16 v[40:55], a[4:7], a[0:3], v[40:55]
    ds_read_b128 a[48:51], v8 offset:32768
    ds_read_b64_tr_b16 a[52:53], v10 offset:39936
    ds_read_b64_tr_b16 a[54:55], v10 offset:40192
    v_mfma_f32_32x32x16_bf16 v[56:71], a[8:11], a[0:3], v[56:71]
    ds_read_b64_tr_b16 a[56:57], v10 offset:44032
    ds_read_b64_tr_b16 a[58:59], v10 offset:44288
    v_mfma_f32_32x32x16_bf16 v[72:87], a[12:15], a[0:3], v[72:87]
    ds_read_b64_tr_b16 a[60:61], v10 offset:48128
    ds_read_b64_tr_b16 a[62:63], v10 offset:48384
    s_waitcnt lgkmcnt(14)
    v_mfma_f32_32x32x16_bf16 v[40:55], a[20:23], a[16:19], v[40:55]
    v_mfma_f32_32x32x16_bf16 v[56:71], a[24:27], a[16:19], v[56:71]
    v_mfma_f32_32x32x16_bf16 v[72:87], a[28:31], a[16:19], v[72:87]
    s_waitcnt lgkmcnt(0)
    s_barrier
    v_mfma_f32_32x32x16_bf16 v[40:55], a[36:39], a[32:35], v[40:55]
    ds_read_b128 a[64:67], v5 offset:49152
    ds_read_b64_tr_b16 a[68:69], v10 offset:12288
    ds_read_b64_tr_b16 a[70:71], v10 offset:12544
    ds_read_b64_tr_b16 a[72:73], v10 offset:16384
    v_mfma_f32_32x32x16_bf16 v[56:71], a[40:43], a[32:35], v[56:71]
    ds_read_b64_tr_b16 a[74:75], v10 offset:16640
    ds_read_b64_tr_b16 a[76:77], v10 offset:20480
    ds_read_b64_tr_b16 a[78:79], v10 offset:20736
    ds_read_b128 a[80:83], v6 offset:49152
    v_mfma_f32_32x32x16_bf16 v[72:87], a[44:47], a[32:35], v[72:87]
    ds_read_b64_tr_b16 a[84:85], v10 offset:13312
    ds_read_b64_tr_b16 a[86:87], v10 offset:13568
    ds_read_b64_tr_b16 a[88:89], v10 offset:17408
    ds_read_b64_tr_b16 a[90:91], v10 offset:17664
    v_mfma_f32_32x32x16_bf16 v[40:55], a[52:55], a[48:51], v[40:55]
    ds_read_b64_tr_b16 a[92:93], v10 offset:21504
    ds_read_b64_tr_b16 a[94:95], v10 offset:21760
    ds_read_b128 a[96:99], v7 offset:49152
    v_mfma_f32_32x32x16_bf16 v[56:71], a[56:59], a[48:51], v[56:71]
    ds_read_b64_tr_b16 a[100:101], v10 offset:14336
    ds_read_b64_tr_b16 a[102:103], v10 offset:14592
    ds_read_b64_tr_b16 a[104:105], v10 offset:18432
    v_mfma_f32_32x32x16_bf16 v[72:87], a[60:63], a[48:51], v[72:87]
    ds_read_b64_tr_b16 a[106:107], v10 offset:18688
    ds_read_b64_tr_b16 a[108:109], v10 offset:22528
    ds_read_b64_tr_b16 a[110:111], v10 offset:22784
    s_waitcnt lgkmcnt(14)
    v_mfma_f32_32x32x16_bf16 v[40:55], a[68:71], a[64:67], v[40:55]
    ds_read_b128 a[112:115], v8 offset:49152
    ds_read_b64_tr_b16 a[116:117], v10 offset:15360
    ds_read_b64_tr_b16 a[118:119], v10 offset:15616
    v_mfma_f32_32x32x16_bf16 v[56:71], a[72:75], a[64:67], v[56:71]
    ds_read_b64_tr_b16 a[120:121], v10 offset:19456
    ds_read_b64_tr_b16 a[122:123], v10 offset:19712
    v_mfma_f32_32x32x16_bf16 v[72:87], a[76:79], a[64:67], v[72:87]
    ds_read_b64_tr_b16 a[124:125], v10 offset:23552
    ds_read_b64_tr_b16 a[126:127], v10 offset:23808
    s_waitcnt lgkmcnt(14)
    v_mfma_f32_32x32x16_bf16 v[40:55], a[84:87], a[80:83], v[40:55]
    v_mfma_f32_32x32x16_bf16 v[56:71], a[88:91], a[80:83], v[56:71]
    v_mfma_f32_32x32x16_bf16 v[72:87], a[92:95], a[80:83], v[72:87]
    s_waitcnt lgkmcnt(0)
    s_barrier
    v_mfma_f32_32x32x16_bf16 v[40:55], a[100:103], a[96:99], v[40:55]
    ds_read_b128 a[0:3], v5 offset:0
    ds_read_b64_tr_b16 a[4:5], v10 offset:24576
    ds_read_b64_tr_b16 a[6:7], v10 offset:24832
    ds_read_b64_tr_b16 a[8:9], v10 offset:28672
    v_mfma_f32_32x32x16_bf16 v[56:71], a[104:107], a[96:99], v[56:71]
    ds_read_b64_tr_b16 a[10:11], v10 offset:28928
    ds_read_b64_tr_b16 a[12:13], v10 offset:32768
    ds_read_b64_tr_b16 a[14:15], v10 offset:33024
    ds_read_b128 a[16:19], v6 offset:0
    v_mfma_f32_32x32x16_bf16 v[72:87], a[108:111], a[96:99], v[72:87]
    ds_read_b64_tr_b16 a[20:21], v10 offset:25600
    ds_read_b64_tr_b16 a[22:23], v10 offset:25856
    ds_read_b64_tr_b16 a[24:25], v10 offset:29696
    ds_read_b64_tr_b16 a[26:27], v10 offset:29952
    v_mfma_f32_32x32x16_bf16 v[40:55], a[116:119], a[112:115], v[40:55]
    ds_read_b64_tr_b16 a[28:29], v10 offset:33792
    ds_read_b64_tr_b16 a[30:31], v10 offset:34048
    ds_read_b128 a[32:35], v7 offset:0
    v_mfma_f32_32x32x16_bf16 v[56:71], a[120:123], a[112:115], v[56:71]
    ds_read_b64_tr_b16 a[36:37], v10 offset:26624
    ds_read_b64_tr_b16 a[38:39], v10 offset:26880
    ds_read_b64_tr_b16 a[40:41], v10 offset:30720
    v_mfma_f32_32x32x16_bf16 v[72:87], a[124:127], a[112:115], v[72:87]
    ds_read_b64_tr_b16 a[42:43], v10 offset:30976
    ds_read_b64_tr_b16 a[44:45], v10 offset:34816
    ds_read_b64_tr_b16 a[46:47], v10 offset:35072
    s_waitcnt lgkmcnt(14)
    v_mfma_f32_32x32x16_bf16 v[40:55], a[4:7], a[0:3], v[40:55]
    ds_read_b128 a[48:51], v8 offset:0
    ds_read_b64_tr_b16 a[52:53], v10 offset:27648
    ds_read_b64_tr_b16 a[54:55], v10 offset:27904
    v_mfma_f32_32x32x16_bf16 v[56:71], a[8:11], a[0:3], v[56:71]
    ds_read_b64_tr_b16 a[56:57], v10 offset:31744
    ds_read_b64_tr_b16 a[58:59], v10 offset:32000
    v_mfma_f32_32x32x16_bf16 v[72:87], a[12:15], a[0:3], v[72:87]
    ds_read_b64_tr_b16 a[60:61], v10 offset:35840
    ds_read_b64_tr_b16 a[62:63], v10 offset:36096
    s_waitcnt lgkmcnt(14)
    v_mfma_f32_32x32x16_bf16 v[40:55], a[20:23], a[16:19], v[40:55]
    v_mfma_f32_32x32x16_bf16 v[56:71], a[24:27], a[16:19], v[56:71]
    v_mfma_f32_32x32x16_bf16 v[72:87], a[28:31], a[16:19], v[72:87]
    s_waitcnt lgkmcnt(0)
    s_barrier
    v_mfma_f32_32x32x16_bf16 v[40:55], a[36:39], a[32:35], v[40:55]
    ds_read_b128 a[64:67], v5 offset:16384
    ds_read_b64_tr_b16 a[68:69], v10 offset:36864
    ds_read_b64_tr_b16 a[70:71], v10 offset:37120
    ds_read_b64_tr_b16 a[72:73], v10 offset:40960
    v_mfma_f32_32x32x16_bf16 v[56:71], a[40:43], a[32:35], v[56:71]
    ds_read_b64_tr_b16 a[74:75], v10 offset:41216
    ds_read_b64_tr_b16 a[76:77], v10 offset:45056
    ds_read_b64_tr_b16 a[78:79], v10 offset:45312
    ds_read_b128 a[80:83], v6 offset:16384
    v_mfma_f32_32x32x16_bf16 v[72:87], a[44:47], a[32:35], v[72:87]
    ds_read_b64_tr_b16 a[84:85], v10 offset:37888
    ds_read_b64_tr_b16 a[86:87], v10 offset:38144
    ds_read_b64_tr_b16 a[88:89], v10 offset:41984
    ds_read_b64_tr_b16 a[90:91], v10 offset:42240
    v_mfma_f32_32x32x16_bf16 v[40:55], a[52:55], a[48:51], v[40:55]
    ds_read_b64_tr_b16 a[92:93], v10 offset:46080
    ds_read_b64_tr_b16 a[94:95], v10 offset:46336
    ds_read_b128 a[96:99], v7 offset:16384
    v_mfma_f32_32x32x16_bf16 v[56:71], a[56:59], a[48:51], v[56:71]
    ds_read_b64_tr_b16 a[100:101], v10 offset:38912
    ds_read_b64_tr_b16 a[102:103], v10 offset:39168
    ds_read_b64_tr_b16 a[104:105], v10 offset:43008
    v_mfma_f32_32x32x16_bf16 v[72:87], a[60:63], a[48:51], v[72:87]
    ds_read_b64_tr_b16 a[106:107], v10 offset:43264
    ds_read_b64_tr_b16 a[108:109], v10 offset:47104
    ds_read_b64_tr_b16 a[110:111], v10 offset:47360
    s_waitcnt lgkmcnt(14)
    v_mfma_f32_32x32x16_bf16 v[40:55], a[68:71], a[64:67], v[40:55]
    ds_read_b128 a[112:115], v8 offset:16384
    ds_read_b64_tr_b16 a[116:117], v10 offset:39936
    ds_read_b64_tr_b16 a[118:119], v10 offset:40192
    v_mfma_f32_32x32x16_bf16 v[56:71], a[72:75], a[64:67], v[56:71]
    ds_read_b64_tr_b16 a[120:121], v10 offset:44032
    ds_read_b64_tr_b16 a[122:123], v10 offset:44288
    v_mfma_f32_32x32x16_bf16 v[72:87], a[76:79], a[64:67], v[72:87]
    ds_read_b64_tr_b16 a[124:125], v10 offset:48128
    ds_read_b64_tr_b16 a[126:127], v10 offset:48384
    s_waitcnt lgkmcnt(14)
    v_mfma_f32_32x32x16_bf16 v[40:55], a[84:87], a[80:83], v[40:55]
    v_mfma_f32_32x32x16_bf16 v[56:71], a[88:91], a[80:83], v[56:71]
    v_mfma_f32_32x32x16_bf16 v[72:87], a[92:95], a[80:83], v[72:87]
    s_waitcnt lgkmcnt(0)
    s_barrier
    v_mfma_f32_32x32x16_bf16 v[40:55], a[100:103], a[96:99], v[40:55]
    ds_read_b128 a[0:3], v5 offset:32768
    ds_read_b64_tr_b16 a[4:5], v10 offset:12288
    ds_read_b64_tr_b16 a[6:7], v10 offset:12544
    ds_read_b64_tr_b16 a[8:9], v10 offset:16384
    v_mfma_f32_32x32x16_bf16 v[56:71], a[104:107], a[96:99], v[56:71]
    ds_read_b64_tr_b16 a[10:11], v10 offset:16640
    ds_read_b64_tr_b16 a[12:13], v10 offset:20480
    ds_read_b64_tr_b16 a[14:15], v10 offset:20736
    ds_read_b128 a[16:19], v6 offset:32768
    v_mfma_f32_32x32x16_bf16 v[72:87], a[108:111], a[96:99], v[72:87]
    ds_read_b64_tr_b16 a[20:21], v10 offset:13312
    ds_read_b64_tr_b16 a[22:23], v10 offset:13568
    ds_read_b64_tr_b16 a[24:25], v10 offset:17408
    ds_read_b64_tr_b16 a[26:27], v10 offset:17664
    v_mfma_f32_32x32x16_bf16 v[40:55], a[116:119], a[112:115], v[40:55]
    ds_read_b64_tr_b16 a[28:29], v10 offset:21504
    ds_read_b64_tr_b16 a[30:31], v10 offset:21760
    ds_read_b128 a[32:35], v7 offset:32768
    v_mfma_f32_32x32x16_bf16 v[56:71], a[120:123], a[112:115], v[56:71]
    ds_read_b64_tr_b16 a[36:37], v10 offset:14336
    ds_read_b64_tr_b16 a[38:39], v10 offset:14592
    ds_read_b64_tr_b16 a[40:41], v10 offset:18432
    v_mfma_f32_32x32x16_bf16 v[72:87], a[124:127], a[112:115], v[72:87]
    ds_read_b64_tr_b16 a[42:43], v10 offset:18688
    ds_read_b64_tr_b16 a[44:45], v10 offset:22528
    ds_read_b64_tr_b16 a[46:47], v10 offset:22784
    s_waitcnt lgkmcnt(14)
    v_mfma_f32_32x32x16_bf16 v[40:55], a[4:7], a[0:3], v[40:55]
    ds_read_b128 a[48:51], v8 offset:32768
    ds_read_b64_tr_b16 a[52:53], v10 offset:15360
    ds_read_b64_tr_b16 a[54:55], v10 offset:15616
    v_mfma_f32_32x32x16_bf16 v[56:71], a[8:11], a[0:3], v[56:71]
    ds_read_b64_tr_b16 a[56:57], v10 offset:19456
    ds_read_b64_tr_b16 a[58:59], v10 offset:19712
    v_mfma_f32_32x32x16_bf16 v[72:87], a[12:15], a[0:3], v[72:87]
    ds_read_b64_tr_b16 a[60:61], v10 offset:23552
    ds_read_b64_tr_b16 a[62:63], v10 offset:23808
    s_waitcnt lgkmcnt(14)
    v_mfma_f32_32x32x16_bf16 v[40:55], a[20:23], a[16:19], v[40:55]
    v_mfma_f32_32x32x16_bf16 v[56:71], a[24:27], a[16:19], v[56:71]
    v_mfma_f32_32x32x16_bf16 v[72:87], a[28:31], a[16:19], v[72:87]
    buffer_load_dwordx2 v[32:33], v3, s[48:51], 0 offen sc1
    s_waitcnt lgkmcnt(0)
    s_barrier
    v_mfma_f32_32x32x16_bf16 v[40:55], a[36:39], a[32:35], v[40:55]
    ds_read_b128 a[64:67], v5 offset:49152
    ds_read_b64_tr_b16 a[68:69], v10 offset:24576
    ds_read_b64_tr_b16 a[70:71], v10 offset:24832
    ds_read_b64_tr_b16 a[72:73], v10 offset:28672
    v_mfma_f32_32x32x16_bf16 v[56:71], a[40:43], a[32:35], v[56:71]
    ds_read_b64_tr_b16 a[74:75], v10 offset:28928
    ds_read_b64_tr_b16 a[76:77], v10 offset:32768
    ds_read_b64_tr_b16 a[78:79], v10 offset:33024
    ds_read_b128 a[80:83], v6 offset:49152
    v_mfma_f32_32x32x16_bf16 v[72:87], a[44:47], a[32:35], v[72:87]
    ds_read_b64_tr_b16 a[84:85], v10 offset:25600
    ds_read_b64_tr_b16 a[86:87], v10 offset:25856
    ds_read_b64_tr_b16 a[88:89], v10 offset:29696
    ds_read_b64_tr_b16 a[90:91], v10 offset:29952
    v_mfma_f32_32x32x16_bf16 v[40:55], a[52:55], a[48:51], v[40:55]
    ds_read_b64_tr_b16 a[92:93], v10 offset:33792
    ds_read_b64_tr_b16 a[94:95], v10 offset:34048
    ds_read_b128 a[96:99], v7 offset:49152
    v_mfma_f32_32x32x16_bf16 v[56:71], a[56:59], a[48:51], v[56:71]
    ds_read_b64_tr_b16 a[100:101], v10 offset:26624
    ds_read_b64_tr_b16 a[102:103], v10 offset:26880
    ds_read_b64_tr_b16 a[104:105], v10 offset:30720
    v_mfma_f32_32x32x16_bf16 v[72:87], a[60:63], a[48:51], v[72:87]
    ds_read_b64_tr_b16 a[106:107], v10 offset:30976
    ds_read_b64_tr_b16 a[108:109], v10 offset:34816
    ds_read_b64_tr_b16 a[110:111], v10 offset:35072
    s_waitcnt lgkmcnt(14)
    v_mfma_f32_32x32x16_bf16 v[40:55], a[68:71], a[64:67], v[40:55]
    ds_read_b128 a[112:115], v8 offset:49152
    ds_read_b64_tr_b16 a[116:117], v10 offset:27648
    ds_read_b64_tr_b16 a[118:119], v10 offset:27904
    v_mfma_f32_32x32x16_bf16 v[56:71], a[72:75], a[64:67], v[56:71]
    ds_read_b64_tr_b16 a[120:121], v10 offset:31744
    ds_read_b64_tr_b16 a[122:123], v10 offset:32000
    v_mfma_f32_32x32x16_bf16 v[72:87], a[76:79], a[64:67], v[72:87]
    ds_read_b64_tr_b16 a[124:125], v10 offset:35840
    ds_read_b64_tr_b16 a[126:127], v10 offset:36096
    s_waitcnt lgkmcnt(14)
    v_mfma_f32_32x32x16_bf16 v[40:55], a[84:87], a[80:83], v[40:55]
    v_mfma_f32_32x32x16_bf16 v[56:71], a[88:91], a[80:83], v[56:71]
    v_mfma_f32_32x32x16_bf16 v[72:87], a[92:95], a[80:83], v[72:87]
    s_waitcnt lgkmcnt(7)
    v_mfma_f32_32x32x16_bf16 v[40:55], a[100:103], a[96:99], v[40:55]
    v_mfma_f32_32x32x16_bf16 v[56:71], a[104:107], a[96:99], v[56:71]
    v_mfma_f32_32x32x16_bf16 v[72:87], a[108:111], a[96:99], v[72:87]
    s_waitcnt lgkmcnt(0)
    v_mfma_f32_32x32x16_bf16 v[40:55], a[116:119], a[112:115], v[40:55]
    v_mfma_f32_32x32x16_bf16 v[56:71], a[120:123], a[112:115], v[56:71]
    v_mfma_f32_32x32x16_bf16 v[72:87], a[124:127], a[112:115], v[72:87]
    s_nop 9
    v_mul_f32 v40, s72, v40
    v_mul_f32 v41, s72, v41
    v_mul_f32 v42, s72, v42
    v_mul_f32 v43, s72, v43
    v_mul_f32 v44, s72, v44
    v_mul_f32 v45, s72, v45
    v_mul_f32 v46, s72, v46
    v_mul_f32 v47, s72, v47
    v_mul_f32 v48, s72, v48
    v_mul_f32 v49, s72, v49
    v_mul_f32 v50, s72, v50
    v_mul_f32 v51, s72, v51
    v_mul_f32 v52, s72, v52
    v_mul_f32 v53, s72, v53
    v_mul_f32 v54, s72, v54
    v_mul_f32 v55, s72, v55
    v_cvt_pk_bf16_f32 v88, v40, v41
    v_cvt_pk_bf16_f32 v89, v42, v43
    v_cvt_pk_bf16_f32 v90, v44, v45
    v_cvt_pk_bf16_f32 v91, v46, v47
    v_cvt_pk_bf16_f32 v92, v48, v49
    v_cvt_pk_bf16_f32 v93, v50, v51
    v_cvt_pk_bf16_f32 v94, v52, v53
    v_cvt_pk_bf16_f32 v95, v54, v55
    buffer_store_dwordx4 v[88:91], v20, s[40:43], s75 offen sc1
    buffer_store_dwordx4 v[92:95], v20, s[40:43], s78 offen sc1
    v_mul_f32 v56, s73, v56
    v_mul_f32 v57, s73, v57
    v_mul_f32 v58, s73, v58
    v_mul_f32 v59, s73, v59
    v_mul_f32 v60, s73, v60
    v_mul_f32 v61, s73, v61
    v_mul_f32 v62, s73, v62
    v_mul_f32 v63, s73, v63
    v_mul_f32 v64, s73, v64
    v_mul_f32 v65, s73, v65
    v_mul_f32 v66, s73, v66
    v_mul_f32 v67, s73, v67
    v_mul_f32 v68, s73, v68
    v_mul_f32 v69, s73, v69
    v_mul_f32 v70, s73, v70
    v_mul_f32 v71, s73, v71
    v_cvt_pk_bf16_f32 v96, v56, v57
    v_cvt_pk_bf16_f32 v97, v58, v59
    v_cvt_pk_bf16_f32 v98, v60, v61
    v_cvt_pk_bf16_f32 v99, v62, v63
    v_cvt_pk_bf16_f32 v100, v64, v65
    v_cvt_pk_bf16_f32 v101, v66, v67
    v_cvt_pk_bf16_f32 v102, v68, v69
    v_cvt_pk_bf16_f32 v103, v70, v71
    buffer_store_dwordx4 v[96:99], v20, s[40:43], s76 offen sc1
    buffer_store_dwordx4 v[100:103], v20, s[40:43], s79 offen sc1
    v_mul_f32 v72, s74, v72
    v_mul_f32 v73, s74, v73
    v_mul_f32 v74, s74, v74
    v_mul_f32 v75, s74, v75
    v_mul_f32 v76, s74, v76
    v_mul_f32 v77, s74, v77
    v_mul_f32 v78, s74, v78
    v_mul_f32 v79, s74, v79
    v_mul_f32 v80, s74, v80
    v_mul_f32 v81, s74, v81
    v_mul_f32 v82, s74, v82
    v_mul_f32 v83, s74, v83
    v_mul_f32 v84, s74, v84
    v_mul_f32 v85, s74, v85
    v_mul_f32 v86, s74, v86
    v_mul_f32 v87, s74, v87
    v_cvt_pk_bf16_f32 v104, v72, v73
    v_cvt_pk_bf16_f32 v105, v74, v75
    v_cvt_pk_bf16_f32 v106, v76, v77
    v_cvt_pk_bf16_f32 v107, v78, v79
    v_cvt_pk_bf16_f32 v108, v80, v81
    v_cvt_pk_bf16_f32 v109, v82, v83
    v_cvt_pk_bf16_f32 v110, v84, v85
    v_cvt_pk_bf16_f32 v111, v86, v87
    buffer_store_dwordx4 v[104:107], v20, s[40:43], s77 offen sc1
    buffer_store_dwordx4 v[108:111], v20, s[40:43], s80 offen sc1
A_post:
    s_mov_b64 exec, 1
    ds_add_u32 v3, v4 offset:8
    s_mov_b64 exec, -1
    s_lshl_b32 s56, s66, 7
    v_add_u32 v16, s56, v34
    ds_read_u16 v112, v16 offset:256
    s_lshl_b32 s56, s67, 7
    v_add_u32 v16, s56, v34
    ds_read_u16 v113, v16 offset:256
    s_waitcnt vmcnt(6)
    v_cmp_eq_u32 vcc, 0, v32
    s_cbranch_vccz A_tagok
A_tagl:
    s_sleep 1
    buffer_load_dwordx2 v[32:33], v3, s[48:51], 0 offen sc1
    s_waitcnt vmcnt(0)
    v_cmp_eq_u32 vcc, 0, v32
    s_cbranch_vccz A_tagok
    s_sub_u32 s3, s3, 1
    s_cbranch_scc0 A_tagl
    s_mov_b32 s3, 0
A_tagok:
    v_readfirstlane_b32 s10, v32
    v_readfirstlane_b32 s11, v33
    ds_write_b64 v3, v[32:33] offset:48
Lw_29:
    ds_read_b32 v12, v3 offset:8
    s_waitcnt lgkmcnt(0)
    v_cmp_gt_u32 vcc, 8, v12
    s_cbranch_vccz Lwd_30
    s_sleep 1
    s_sub_u32 s3, s3, 1
    s_cbranch_scc0 Lw_29
    s_mov_b32 s3, 0
Lwd_30:
    s_mul_i32 s56, s66, 229376
    s_add_u32 s56, s56, s84
    s_add_u32 m0, s86, 61440
    s_nop 0
    buffer_load_dwordx4 v30, s[36:39], s56 offen lds
    s_add_u32 s56, s56, 64
    s_add_u32 m0, s86, 65536
    s_nop 0
    buffer_load_dwordx4 v30, s[36:39], s56 offen lds
    s_add_u32 s56, s56, 64
    s_add_u32 m0, s86, 69632
    s_nop 0
    buffer_load_dwordx4 v30, s[36:39], s56 offen lds
    s_add_u32 s56, s56, 64
    s_add_u32 m0, s86, 73728
    s_mov_b32 exec_lo, 0x33333333
    s_mov_b32 exec_hi, 0x33333333
    buffer_load_dwordx4 v30, s[36:39], s56 offen lds
    s_add_u32 s56, s56, 64
    s_mov_b32 exec_lo, -1
    s_mov_b32 exec_hi, 0
    ds_write_b16 v31, v112 offset:0
    s_mov_b64 exec, -1
    s_mul_i32 s56, s67, 229376
    s_add_u32 s56, s56, s84
    s_add_u32 m0, s86, 77824
    s_nop 0
    buffer_load_dwordx4 v30, s[36:39], s56 offen lds
    s_add_u32 s56, s56, 64
    s_add_u32 m0, s86, 81920
    s_nop 0
    buffer_load_dwordx4 v30, s[36:39], s56 offen lds
    s_add_u32 s56, s56, 64
    s_add_u32 m0, s86, 86016
    s_nop 0
    buffer_load_dwordx4 v30, s[36:39], s56 offen lds
    s_add_u32 s56, s56, 64
    s_add_u32 m0, s86, 90112
    s_mov_b32 exec_lo, 0x33333333
    s_mov_b32 exec_hi, 0x33333333
    buffer_load_dwordx4 v30, s[36:39], s56 offen lds
    s_add_u32 s56, s56, 64
    s_mov_b32 exec_lo, -1
    s_mov_b32 exec_hi, 0
    ds_write_b16 v31, v113 offset:16384
    s_mov_b64 exec, -1
    v_accvgpr_write_b32 a32, 0
    v_accvgpr_write_b32 a33, 0
    v_accvgpr_write_b32 a34, 0
    v_accvgpr_write_b32 a35, 0
    v_accvgpr_write_b32 a36, 0
    v_accvgpr_write_b32 a37, 0
    v_accvgpr_write_b32 a38, 0
    v_accvgpr_write_b32 a39, 0
    v_accvgpr_write_b32 a40, 0
    v_accvgpr_write_b32 a41, 0
    v_accvgpr_write_b32 a42, 0
    v_accvgpr_write_b32 a43, 0
    v_accvgpr_write_b32 a44, 0
    v_accvgpr_write_b32 a45, 0
    v_accvgpr_write_b32 a46, 0
    v_accvgpr_write_b32 a47, 0
    v_accvgpr_write_b32 a48, 0
    v_accvgpr_write_b32 a49, 0
    v_accvgpr_write_b32 a50, 0
    v_accvgpr_write_b32 a51, 0
    v_accvgpr_write_b32 a52, 0
    v_accvgpr_write_b32 a53, 0
    v_accvgpr_write_b32 a54, 0
    v_accvgpr_write_b32 a55, 0
    v_accvgpr_write_b32 a56, 0
    v_accvgpr_write_b32 a57, 0
    v_accvgpr_write_b32 a58, 0
    v_accvgpr_write_b32 a59, 0
    v_accvgpr_write_b32 a60, 0
    v_accvgpr_write_b32 a61, 0
    v_accvgpr_write_b32 a62, 0
    v_accvgpr_write_b32 a63, 0
    v_accvgpr_write_b32 a24, 0
    v_accvgpr_write_b32 a25, 0
    v_accvgpr_write_b32 a26, 0
    v_accvgpr_write_b32 a27, 0
    v_accvgpr_write_b32 a28, 0
    v_accvgpr_write_b32 a29, 0
    v_accvgpr_write_b32 a30, 0
    v_accvgpr_write_b32 a31, 0
    s_lshl_b32 s56, s68, 17
    s_add_u32 s83, s56, 0x200000
    s_lshl_b32 s57, s52, 11
    s_add_u32 s75, s57, s83
    s_mul_i32 s76, s52, 2080
    s_lshl_b32 s77, s68, 16
    s_lshl_b32 s59, s69, 13
    s_add_u32 s77, s77, s59
    s_add_u32 s77, s77, s57
    s_waitcnt vmcnt(8)
    v_mov_b32 v14, s10
    v_mov_b32 v15, s11
    s_lshl_b32 s85, s85, 8
    s_add_u32 s85, s85, 0x1400000
    s_mov_b64 exec, 1
    buffer_store_dwordx2 v[14:15], v3, s[40:43], s85 offen sc1
    s_mov_b64 exec, -1
    s_waitcnt vmcnt(1)
    s_mov_b64 exec, 1
    ds_add_u32 v3, v4 offset:56
    s_mov_b64 exec, -1
    s_mov_b32 s59, 0x1400000
Lp_31:
    buffer_load_dwordx2 v[12:13], v22, s[40:43], s59 offen sc1
    s_waitcnt vmcnt(0)
    v_cmp_ne_u64 vcc, s[10:11], v[12:13]
    s_cbranch_vccz Lpd_32
    s_sleep 1
    s_sub_u32 s3, s3, 1
    s_cbranch_scc0 Lp_31
    s_mov_b32 s3, 0
Lpd_32:
Lw_33:
    ds_read_b32 v12, v3 offset:40
    s_waitcnt lgkmcnt(0)
    v_cmp_gt_u32 vcc, 4, v12
    s_cbranch_vccz Lwd_34
    s_sleep 1
    s_sub_u32 s3, s3, 1
    s_cbranch_scc0 Lw_33
    s_mov_b32 s3, 0
Lwd_34:
    s_mov_b32 exec_lo, -1
    s_mov_b32 exec_hi, 0xff
    ds_write_b128 v29, v[36:39] offset:2304
    s_mov_b64 exec, -1
    s_add_u32 m0, s76, 256
    s_nop 0
    buffer_load_dwordx4 v2, s[40:43], s75 offen sc1 lds
    buffer_load_dwordx4 v2, s[40:43], s75 offen offset:1024 sc1 lds
    s_add_u32 s75, s75, 8192
    buffer_load_dwordx4 a[0:3], v20, s[40:43], s77 offen sc1
    buffer_load_dwordx4 a[4:7], v20, s[40:43], s77 offen offset:1024 sc1
    s_add_u32 m0, s76, 8576
    s_nop 0
    buffer_load_dwordx4 v2, s[40:43], s75 offen sc1 lds
    buffer_load_dwordx4 v2, s[40:43], s75 offen offset:1024 sc1 lds
    s_add_u32 s75, s75, 8192
    s_add_u32 m0, s76, 16896
    s_nop 0
    buffer_load_dwordx4 v2, s[40:43], s75 offen sc1 lds
    buffer_load_dwordx4 v2, s[40:43], s75 offen offset:1024 sc1 lds
    s_add_u32 s75, s75, 8192
    s_add_u32 m0, s76, 25216
    s_nop 0
    buffer_load_dwordx4 v2, s[40:43], s75 offen sc1 lds
    buffer_load_dwordx4 v2, s[40:43], s75 offen offset:1024 sc1 lds
    s_add_u32 s75, s75, 8192
    s_add_u32 m0, s76, 33536
    s_nop 0
    buffer_load_dwordx4 v2, s[40:43], s75 offen sc1 lds
    buffer_load_dwordx4 v2, s[40:43], s75 offen offset:1024 sc1 lds
    s_add_u32 s75, s75, 8192
    s_waitcnt vmcnt(8)
    s_mov_b64 exec, 1
    ds_add_u32 v3, v4 offset:60
    s_mov_b64 exec, -1
Lw_35:
    ds_read_b32 v12, v3 offset:60
    s_waitcnt lgkmcnt(0)
    v_cmp_gt_u32 vcc, 4, v12
    s_cbranch_vccz Lwd_36
    s_sleep 1
    s_sub_u32 s3, s3, 1
    s_cbranch_scc0 Lw_35
    s_mov_b32 s3, 0
Lwd_36:
    ds_read_b128 a[8:11], v25
    ds_read_b128 a[12:15], v25 offset:2080
    ds_read_b128 a[16:19], v26
    ds_read_b128 a[20:23], v27
    s_waitcnt lgkmcnt(3)
    v_mfma_f32_32x32x16_bf16 v[64:79], a[8:11], a[0:3], 0
    v_mfma_f32_32x32x16_bf16 v[80:95], a[8:11], a[4:7], 0
    s_nop 11
    v_max_f32 v12, v64, v65
    v_max3_f32 v12, v12, v66, v67
    v_max3_f32 v12, v12, v68, v69
    v_max3_f32 v12, v12, v70, v71
    v_max3_f32 v12, v12, v72, v73
    v_max3_f32 v12, v12, v74, v75
    v_max3_f32 v12, v12, v76, v77
    v_max3_f32 v12, v12, v78, v79
    v_mov_b32 v13, v12
    s_nop 1
    v_permlane32_swap_b32 v12, v13
    s_nop 1
    v_max_f32 v12, v12, v13
    v_sub_f32 v96, 0, v12
    v_mov_b32 v97, v96
    v_mov_b32 v98, v96
    v_mov_b32 v99, v96
    v_mov_b32 v100, v96
    v_mov_b32 v101, v96
    v_mov_b32 v102, v96
    v_mov_b32 v103, v96
    v_mov_b32 v104, v96
    v_mov_b32 v105, v96
    v_mov_b32 v106, v96
    v_mov_b32 v107, v96
    v_mov_b32 v108, v96
    v_mov_b32 v109, v96
    v_mov_b32 v110, v96
    v_mov_b32 v111, v96
    s_nop 1
    v_mfma_f32_32x32x16_bf16 v[64:79], a[8:11], a[0:3], v[96:111]
    v_max_f32 v14, v80, v81
    v_max3_f32 v14, v14, v82, v83
    v_max3_f32 v14, v14, v84, v85
    v_max3_f32 v14, v14, v86, v87
    v_max3_f32 v14, v14, v88, v89
    v_max3_f32 v14, v14, v90, v91
    v_max3_f32 v14, v14, v92, v93
    v_max3_f32 v14, v14, v94, v95
    v_mov_b32 v15, v14
    s_nop 1
    v_permlane32_swap_b32 v14, v15
    s_nop 1
    v_max_f32 v14, v14, v15
    v_sub_f32 v112, 0, v14
    v_mov_b32 v113, v112
    v_mov_b32 v114, v112
    v_mov_b32 v115, v112
    v_mov_b32 v116, v112
    v_mov_b32 v117, v112
    v_mov_b32 v118, v112
    v_mov_b32 v119, v112
    v_mov_b32 v120, v112
    v_mov_b32 v121, v112
    v_mov_b32 v122, v112
    v_mov_b32 v123, v112
    v_mov_b32 v124, v112
    v_mov_b32 v125, v112
    v_mov_b32 v126, v112
    v_mov_b32 v127, v112
    v_mov_b32 v88, 0
    v_mov_b32 v89, 0
    v_mov_b32 v90, 0
    v_mov_b32 v91, 0
    v_mov_b32 v92, 0
    v_mov_b32 v93, 0
    v_mov_b32 v94, 0
    v_mov_b32 v95, 0
    s_waitcnt vmcnt(0)
    s_mov_b64 exec, 1
    ds_add_u32 v3, v4 offset:4
    s_mov_b64 exec, -1
Lw_37:
    ds_read_b32 v12, v3 offset:4
    s_waitcnt lgkmcnt(0)
    v_cmp_gt_u32 vcc, 4, v12
    s_cbranch_vccz Lwd_38
    s_sleep 1
    s_sub_u32 s3, s3, 1
    s_cbranch_scc0 Lw_37
    s_mov_b32 s3, 0
Lwd_38:
    s_setprio 0
    s_mov_b32 s81, 2
    s_mov_b32 s82, 1
.p2align 6
A_loop:
    v_exp_f32 v64, v64
    v_exp_f32 v65, v65
    v_exp_f32 v66, v66
    v_exp_f32 v67, v67
    v_smfmac_f32_32x32x32_bf16 a[48:63], a[28:31], v[88:95], v28
    v_exp_f32 v68, v68
    v_exp_f32 v69, v69
    v_exp_f32 v70, v70
    v_exp_f32 v71, v71
    v_mfma_f32_32x32x16_bf16 v[80:95], a[8:11], a[4:7], v[112:127]
    s_waitcnt lgkmcnt(0)
    ds_read_b128 a[24:27], v26 offset:2080
    ds_read_b128 a[28:31], v27 offset:2080
    ds_read_b128 a[8:11], v25 offset:4160
    v_exp_f32 v72, v72
    v_exp_f32 v73, v73
    v_exp_f32 v74, v74
    v_exp_f32 v75, v75
    v_smfmac_f32_32x32x32_bf16 a[32:47], a[16:19], v[64:71], v28
    v_exp_f32 v76, v76
    v_exp_f32 v77, v77
    v_exp_f32 v78, v78
    v_exp_f32 v79, v79
    v_exp_f32 v80, v80
    v_exp_f32 v81, v81
    v_smfmac_f32_32x32x32_bf16 a[32:47], a[20:23], v[72:79], v28
    v_exp_f32 v82, v82
    v_exp_f32 v83, v83
    v_exp_f32 v84, v84
    v_mfma_f32_32x32x16_bf16 v[64:79], a[12:15], a[0:3], v[96:111]
    v_exp_f32 v85, v85
    v_exp_f32 v86, v86
    v_exp_f32 v87, v87
    v_exp_f32 v88, v88
    v_exp_f32 v89, v89
    v_smfmac_f32_32x32x32_bf16 a[48:63], a[16:19], v[80:87], v28
    v_exp_f32 v90, v90
    v_exp_f32 v91, v91
    v_exp_f32 v92, v92
    v_exp_f32 v93, v93
    v_exp_f32 v94, v94
    v_exp_f32 v95, v95
    v_exp_f32 v64, v64
    v_exp_f32 v65, v65
    v_exp_f32 v66, v66
    v_exp_f32 v67, v67
    v_smfmac_f32_32x32x32_bf16 a[48:63], a[20:23], v[88:95], v28
    v_exp_f32 v68, v68
    v_exp_f32 v69, v69
    v_exp_f32 v70, v70
    v_exp_f32 v71, v71
    v_mfma_f32_32x32x16_bf16 v[80:95], a[12:15], a[4:7], v[112:127]
    s_waitcnt lgkmcnt(0)
    ds_read_b128 a[16:19], v26 offset:4160
    ds_read_b128 a[20:23], v27 offset:4160
    ds_read_b128 a[12:15], v25 offset:6240
    v_exp_f32 v72, v72
    v_exp_f32 v73, v73
    v_exp_f32 v74, v74
    v_exp_f32 v75, v75
    v_smfmac_f32_32x32x32_bf16 a[32:47], a[24:27], v[64:71], v28
    v_exp_f32 v76, v76
    v_exp_f32 v77, v77
    v_exp_f32 v78, v78
    v_exp_f32 v79, v79
    v_exp_f32 v80, v80
    v_exp_f32 v81, v81
    v_smfmac_f32_32x32x32_bf16 a[32:47], a[28:31], v[72:79], v28
    v_exp_f32 v82, v82
    v_exp_f32 v83, v83
    v_exp_f32 v84, v84
    v_mfma_f32_32x32x16_bf16 v[64:79], a[8:11], a[0:3], v[96:111]
    v_exp_f32 v85, v85
    v_exp_f32 v86, v86
    v_exp_f32 v87, v87
    v_exp_f32 v88, v88
    v_exp_f32 v89, v89
    v_smfmac_f32_32x32x32_bf16 a[48:63], a[24:27], v[80:87], v28
    v_exp_f32 v90, v90
    v_exp_f32 v91, v91
    v_exp_f32 v92, v92
    v_exp_f32 v93, v93
    v_exp_f32 v94, v94
    v_exp_f32 v95, v95
    v_exp_f32 v64, v64
    v_exp_f32 v65, v65
    v_exp_f32 v66, v66
    v_exp_f32 v67, v67
    v_smfmac_f32_32x32x32_bf16 a[48:63], a[28:31], v[88:95], v28
    v_exp_f32 v68, v68
    v_exp_f32 v69, v69
    v_exp_f32 v70, v70
    v_exp_f32 v71, v71
    v_mfma_f32_32x32x16_bf16 v[80:95], a[8:11], a[4:7], v[112:127]
    s_waitcnt lgkmcnt(0)
    ds_read_b128 a[24:27], v26 offset:6240
    ds_read_b128 a[28:31], v27 offset:6240
    ds_read_b128 a[8:11], v25 offset:8320
    v_exp_f32 v72, v72
    v_exp_f32 v73, v73
    v_exp_f32 v74, v74
    v_exp_f32 v75, v75
    v_smfmac_f32_32x32x32_bf16 a[32:47], a[16:19], v[64:71], v28
    v_exp_f32 v76, v76
    v_exp_f32 v77, v77
    v_exp_f32 v78, v78
    v_exp_f32 v79, v79
    v_exp_f32 v80, v80
    v_exp_f32 v81, v81
    v_smfmac_f32_32x32x32_bf16 a[32:47], a[20:23], v[72:79], v28
    v_exp_f32 v82, v82
    v_exp_f32 v83, v83
    v_exp_f32 v84, v84
    v_mfma_f32_32x32x16_bf16 v[64:79], a[12:15], a[0:3], v[96:111]
    v_exp_f32 v85, v85
    v_exp_f32 v86, v86
    v_exp_f32 v87, v87
    v_exp_f32 v88, v88
    v_exp_f32 v89, v89
    v_smfmac_f32_32x32x32_bf16 a[48:63], a[16:19], v[80:87], v28
    v_exp_f32 v90, v90
    v_exp_f32 v91, v91
    v_exp_f32 v92, v92
    v_exp_f32 v93, v93
    v_exp_f32 v94, v94
    v_exp_f32 v95, v95
    v_exp_f32 v64, v64
    v_exp_f32 v65, v65
    v_exp_f32 v66, v66
    v_exp_f32 v67, v67
    v_smfmac_f32_32x32x32_bf16 a[48:63], a[20:23], v[88:95], v28
    v_exp_f32 v68, v68
    v_exp_f32 v69, v69
    v_exp_f32 v70, v70
    v_exp_f32 v71, v71
    v_mfma_f32_32x32x16_bf16 v[80:95], a[12:15], a[4:7], v[112:127]
    s_waitcnt lgkmcnt(0)
    ds_read_b128 a[16:19], v26 offset:8320
    ds_read_b128 a[20:23], v27 offset:8320
    ds_read_b128 a[12:15], v25 offset:10400
    v_exp_f32 v72, v72
    v_exp_f32 v73, v73
    v_exp_f32 v74, v74
    v_exp_f32 v75, v75
    v_smfmac_f32_32x32x32_bf16 a[32:47], a[24:27], v[64:71], v28
    v_exp_f32 v76, v76
    v_exp_f32 v77, v77
    v_exp_f32 v78, v78
    v_exp_f32 v79, v79
    v_exp_f32 v80, v80
    v_exp_f32 v81, v81
    v_smfmac_f32_32x32x32_bf16 a[32:47], a[28:31], v[72:79], v28
    v_exp_f32 v82, v82
    v_exp_f32 v83, v83
    v_exp_f32 v84, v84
    v_mfma_f32_32x32x16_bf16 v[64:79], a[8:11], a[0:3], v[96:111]
    v_exp_f32 v85, v85
    v_exp_f32 v86, v86
    v_exp_f32 v87, v87
    v_exp_f32 v88, v88
    v_exp_f32 v89, v89
    v_smfmac_f32_32x32x32_bf16 a[48:63], a[24:27], v[80:87], v28
    v_exp_f32 v90, v90
    v_exp_f32 v91, v91
    v_exp_f32 v92, v92
    v_exp_f32 v93, v93
    v_exp_f32 v94, v94
    v_exp_f32 v95, v95
    v_exp_f32 v64, v64
    v_exp_f32 v65, v65
    v_exp_f32 v66, v66
    v_exp_f32 v67, v67
    v_smfmac_f32_32x32x32_bf16 a[48:63], a[28:31], v[88:95], v28
    v_exp_f32 v68, v68
    v_exp_f32 v69, v69
    v_exp_f32 v70, v70
    v_exp_f32 v71, v71
    v_mfma_f32_32x32x16_bf16 v[80:95], a[8:11], a[4:7], v[112:127]
    s_waitcnt lgkmcnt(0)
    ds_read_b128 a[24:27], v26 offset:10400
    ds_read_b128 a[28:31], v27 offset:10400
    ds_read_b128 a[8:11], v25 offset:12480
    v_exp_f32 v72, v72
    v_exp_f32 v73, v73
    v_exp_f32 v74, v74
    v_exp_f32 v75, v75
    v_smfmac_f32_32x32x32_bf16 a[32:47], a[16:19], v[64:71], v28
    v_exp_f32 v76, v76
    v_exp_f32 v77, v77
    v_exp_f32 v78, v78
    v_exp_f32 v79, v79
    v_exp_f32 v80, v80
    v_exp_f32 v81, v81
    v_smfmac_f32_32x32x32_bf16 a[32:47], a[20:23], v[72:79], v28
    v_exp_f32 v82, v82
    v_exp_f32 v83, v83
    v_exp_f32 v84, v84
    v_mfma_f32_32x32x16_bf16 v[64:79], a[12:15], a[0:3], v[96:111]
    v_exp_f32 v85, v85
    v_exp_f32 v86, v86
    v_exp_f32 v87, v87
    v_exp_f32 v88, v88
    v_exp_f32 v89, v89
    v_smfmac_f32_32x32x32_bf16 a[48:63], a[16:19], v[80:87], v28
    v_exp_f32 v90, v90
    v_exp_f32 v91, v91
    v_exp_f32 v92, v92
    v_exp_f32 v93, v93
    v_exp_f32 v94, v94
    v_exp_f32 v95, v95
    v_exp_f32 v64, v64
    v_exp_f32 v65, v65
    v_exp_f32 v66, v66
    v_exp_f32 v67, v67
    v_smfmac_f32_32x32x32_bf16 a[48:63], a[20:23], v[88:95], v28
    v_exp_f32 v68, v68
    v_exp_f32 v69, v69
    v_exp_f32 v70, v70
    v_exp_f32 v71, v71
    v_mfma_f32_32x32x16_bf16 v[80:95], a[12:15], a[4:7], v[112:127]
    s_waitcnt lgkmcnt(0)
    ds_read_b128 a[16:19], v26 offset:12480
    ds_read_b128 a[20:23], v27 offset:12480
    ds_read_b128 a[12:15], v25 offset:14560
    v_exp_f32 v72, v72
    v_exp_f32 v73, v73
    v_exp_f32 v74, v74
    v_exp_f32 v75, v75
    v_smfmac_f32_32x32x32_bf16 a[32:47], a[24:27], v[64:71], v28
    v_exp_f32 v76, v76
    v_exp_f32 v77, v77
    v_exp_f32 v78, v78
    v_exp_f32 v79, v79
    v_exp_f32 v80, v80
    v_exp_f32 v81, v81
    v_smfmac_f32_32x32x32_bf16 a[32:47], a[28:31], v[72:79], v28
    v_exp_f32 v82, v82
    v_exp_f32 v83, v83
    v_exp_f32 v84, v84
    v_mfma_f32_32x32x16_bf16 v[64:79], a[8:11], a[0:3], v[96:111]
    v_exp_f32 v85, v85
    v_exp_f32 v86, v86
    v_exp_f32 v87, v87
    v_exp_f32 v88, v88
    v_exp_f32 v89, v89
    v_smfmac_f32_32x32x32_bf16 a[48:63], a[24:27], v[80:87], v28
    v_exp_f32 v90, v90
    v_exp_f32 v91, v91
    v_exp_f32 v92, v92
    v_exp_f32 v93, v93
    v_exp_f32 v94, v94
    v_exp_f32 v95, v95
    v_exp_f32 v64, v64
    v_exp_f32 v65, v65
    v_exp_f32 v66, v66
    v_exp_f32 v67, v67
    v_smfmac_f32_32x32x32_bf16 a[48:63], a[28:31], v[88:95], v28
    v_exp_f32 v68, v68
    v_exp_f32 v69, v69
    v_exp_f32 v70, v70
    v_exp_f32 v71, v71
    v_mfma_f32_32x32x16_bf16 v[80:95], a[8:11], a[4:7], v[112:127]
    s_waitcnt lgkmcnt(0)
    ds_read_b128 a[24:27], v26 offset:14560
    ds_read_b128 a[28:31], v27 offset:14560
    ds_read_b128 a[8:11], v25 offset:16640
    v_exp_f32 v72, v72
    v_exp_f32 v73, v73
    v_exp_f32 v74, v74
    v_exp_f32 v75, v75
    v_smfmac_f32_32x32x32_bf16 a[32:47], a[16:19], v[64:71], v28
    v_exp_f32 v76, v76
    v_exp_f32 v77, v77
    v_exp_f32 v78, v78
    v_exp_f32 v79, v79
    v_exp_f32 v80, v80
    v_exp_f32 v81, v81
    v_smfmac_f32_32x32x32_bf16 a[32:47], a[20:23], v[72:79], v28
    v_exp_f32 v82, v82
    v_exp_f32 v83, v83
    v_exp_f32 v84, v84
    v_mfma_f32_32x32x16_bf16 v[64:79], a[12:15], a[0:3], v[96:111]
    v_exp_f32 v85, v85
    v_exp_f32 v86, v86
    v_exp_f32 v87, v87
    v_exp_f32 v88, v88
    v_exp_f32 v89, v89
    v_smfmac_f32_32x32x32_bf16 a[48:63], a[16:19], v[80:87], v28
    v_exp_f32 v90, v90
    v_exp_f32 v91, v91
    v_exp_f32 v92, v92
    v_exp_f32 v93, v93
    v_exp_f32 v94, v94
    v_exp_f32 v95, v95
    v_exp_f32 v64, v64
    v_exp_f32 v65, v65
    v_exp_f32 v66, v66
    v_exp_f32 v67, v67
    v_smfmac_f32_32x32x32_bf16 a[48:63], a[20:23], v[88:95], v28
    v_exp_f32 v68, v68
    v_exp_f32 v69, v69
    v_exp_f32 v70, v70
    v_exp_f32 v71, v71
    v_mfma_f32_32x32x16_bf16 v[80:95], a[12:15], a[4:7], v[112:127]
    s_waitcnt lgkmcnt(0)
    ds_read_b128 a[16:19], v26 offset:16640
    ds_read_b128 a[20:23], v27 offset:16640
    ds_read_b128 a[12:15], v25 offset:18720
    v_exp_f32 v72, v72
    v_exp_f32 v73, v73
    v_exp_f32 v74, v74
    v_exp_f32 v75, v75
    v_smfmac_f32_32x32x32_bf16 a[32:47], a[24:27], v[64:71], v28
    v_exp_f32 v76, v76
    v_exp_f32 v77, v77
    v_exp_f32 v78, v78
    v_exp_f32 v79, v79
    v_exp_f32 v80, v80
    v_exp_f32 v81, v81
    v_smfmac_f32_32x32x32_bf16 a[32:47], a[28:31], v[72:79], v28
    v_exp_f32 v82, v82
    v_exp_f32 v83, v83
    v_exp_f32 v84, v84
    v_mfma_f32_32x32x16_bf16 v[64:79], a[8:11], a[0:3], v[96:111]
    v_exp_f32 v85, v85
    v_exp_f32 v86, v86
    v_exp_f32 v87, v87
    v_exp_f32 v88, v88
    v_exp_f32 v89, v89
    v_smfmac_f32_32x32x32_bf16 a[48:63], a[24:27], v[80:87], v28
    v_exp_f32 v90, v90
    v_exp_f32 v91, v91
    v_exp_f32 v92, v92
    v_exp_f32 v93, v93
    v_exp_f32 v94, v94
    v_exp_f32 v95, v95
    v_add_u32 v25, 16640, v25
    v_add_u32 v26, 16640, v26
    v_add_u32 v27, 16640, v27
    s_sub_u32 s81, s81, 1
    s_cmp_lg_u32 s81, 0
    s_cbranch_scc1 A_loop
    s_add_u32 s82, s82, 1
A_ph2:
    s_cmp_eq_u32 s82, 2
    s_cbranch_scc0 A_ph3
Lw_39:
    ds_read_b32 v12, v3 offset:20
    s_waitcnt lgkmcnt(0)
    v_cmp_gt_u32 vcc, 4, v12
    s_cbranch_vccz Lwd_40
    s_sleep 0
    s_sub_u32 s3, s3, 1
    s_cbranch_scc0 Lw_39
    s_mov_b32 s3, 0
Lwd_40:
    s_mov_b32 s81, 3
    s_branch A_loop
A_ph3:
    s_cmp_eq_u32 s82, 3
    s_cbranch_scc0 A_done
    s_mov_b64 exec, 1
    ds_add_u32 v3, v4 offset:24
    s_mov_b64 exec, -1
    s_mov_b32 s81, 3
    s_branch A_loop
A_done:
    v_smfmac_f32_32x32x32_bf16 a[48:63], a[28:31], v[88:95], v28
    s_setprio 3
    s_mov_b64 exec, 1
    ds_add_u32 v3, v4 offset:0
    s_mov_b64 exec, -1
    s_lshl_b32 s56, s69, 3
    s_lshl_b32 s57, s52, 1
    s_add_u32 s56, s56, s57
    s_lshl_b32 s75, s56, 15
    s_lshl_b32 s57, s68, 10
    s_add_u32 s75, s75, s57
    s_add_u32 s75, s75, 0x1100000
    s_add_u32 s76, s75, 32768
    s_lshl_b32 s77, s56, 4
    s_add_u32 s77, s77, s68
    s_add_u32 s77, s77, 2048
    s_mov_b32 s58, 0x71800000
A_fin:
    v_accvgpr_read_b32 v40, a32
    v_accvgpr_read_b32 v41, a33
    v_accvgpr_read_b32 v42, a34
    v_accvgpr_read_b32 v43, a35
    v_accvgpr_read_b32 v44, a36
    v_accvgpr_read_b32 v45, a37
    v_accvgpr_read_b32 v46, a38
    v_accvgpr_read_b32 v47, a39
    v_accvgpr_read_b32 v48, a40
    v_accvgpr_read_b32 v56, a48
    v_accvgpr_read_b32 v57, a49
    v_accvgpr_read_b32 v58, a50
    v_accvgpr_read_b32 v59, a51
    v_accvgpr_read_b32 v60, a52
    v_accvgpr_read_b32 v61, a53
    v_accvgpr_read_b32 v62, a54
    v_accvgpr_read_b32 v63, a55
    v_accvgpr_read_b32 v64, a56
    v_add_f32 v12, v48, v64
    v_add_f32 v12, v12, abs(v40)
    v_add_f32 v12, v12, abs(v41)
    v_add_f32 v12, v12, abs(v42)
    v_add_f32 v12, v12, abs(v43)
    v_add_f32 v12, v12, abs(v44)
    v_add_f32 v12, v12, abs(v45)
    v_add_f32 v12, v12, abs(v46)
    v_add_f32 v12, v12, abs(v47)
    v_add_f32 v12, v12, abs(v56)
    v_add_f32 v12, v12, abs(v57)
    v_add_f32 v12, v12, abs(v58)
    v_add_f32 v12, v12, abs(v59)
    v_add_f32 v12, v12, abs(v60)
    v_add_f32 v12, v12, abs(v61)
    v_add_f32 v12, v12, abs(v62)
    v_add_f32 v12, v12, abs(v63)
    v_cmp_nlt_f32 vcc, v12, s58
    s_cmp_eq_u32 s82, 4
    s_cbranch_scc0 A_norm
    s_cbranch_vccnz A_fallback
A_norm:
    v_rcp_f32 v49, v48
    s_nop 0
    v_mul_f32 v40, v40, v49
    v_mul_f32 v41, v41, v49
    v_mul_f32 v42, v42, v49
    v_mul_f32 v43, v43, v49
    v_mul_f32 v44, v44, v49
    v_mul_f32 v45, v45, v49
    v_mul_f32 v46, v46, v49
    v_mul_f32 v47, v47, v49
    v_cvt_pk_bf16_f32 v52, v40, v41
    v_cvt_pk_bf16_f32 v53, v42, v43
    v_cvt_pk_bf16_f32 v54, v44, v45
    v_cvt_pk_bf16_f32 v55, v46, v47
    buffer_store_dwordx4 v[52:55], v2, s[40:43], s75 offen sc1
    v_rcp_f32 v65, v64
    s_nop 0
    v_mul_f32 v56, v56, v65
    v_mul_f32 v57, v57, v65
    v_mul_f32 v58, v58, v65
    v_mul_f32 v59, v59, v65
    v_mul_f32 v60, v60, v65
    v_mul_f32 v61, v61, v65
    v_mul_f32 v62, v62, v65
    v_mul_f32 v63, v63, v65
    v_cvt_pk_bf16_f32 v68, v56, v57
    v_cvt_pk_bf16_f32 v69, v58, v59
    v_cvt_pk_bf16_f32 v70, v60, v61
    v_cvt_pk_bf16_f32 v71, v62, v63
    buffer_store_dwordx4 v[68:71], v2, s[40:43], s76 offen sc1
    s_waitcnt vmcnt(0)
    v_mov_b32 v14, s10
    v_mov_b32 v15, s11
    s_lshl_b32 s77, s77, 8
    s_add_u32 s77, s77, 0x1400000
    s_mov_b64 exec, 1
    buffer_store_dwordx2 v[14:15], v3, s[40:43], s77 offen sc1
    s_mov_b64 exec, -1
    s_endpgm
A_fallback:
    s_mov_b32 s82, 5
    v_mov_b32 v12, 0xff800000
    v_mov_b32 v14, 0xff800000
    s_mov_b32 s56, s83
    s_mov_b32 s81, 64
    s_waitcnt lgkmcnt(0)
A_fb1:
    buffer_load_dwordx4 a[8:11], v2, s[40:43], s56 offen sc1
    s_add_u32 s56, s56, 2048
    s_waitcnt vmcnt(0)
    v_mfma_f32_32x32x16_bf16 v[64:79], a[8:11], a[0:3], 0
    v_mfma_f32_32x32x16_bf16 v[80:95], a[8:11], a[4:7], 0
    s_nop 15
    v_max3_f32 v12, v12, v64, v65
    v_max3_f32 v12, v12, v66, v67
    v_max3_f32 v12, v12, v68, v69
    v_max3_f32 v12, v12, v70, v71
    v_max3_f32 v12, v12, v72, v73
    v_max3_f32 v12, v12, v74, v75
    v_max3_f32 v12, v12, v76, v77
    v_max3_f32 v12, v12, v78, v79
    v_max3_f32 v14, v14, v80, v81
    v_max3_f32 v14, v14, v82, v83
    v_max3_f32 v14, v14, v84, v85
    v_max3_f32 v14, v14, v86, v87
    v_max3_f32 v14, v14, v88, v89
    v_max3_f32 v14, v14, v90, v91
    v_max3_f32 v14, v14, v92, v93
    v_max3_f32 v14, v14, v94, v95
    s_sub_u32 s81, s81, 1
    s_cmp_lg_u32 s81, 0
    s_cbranch_scc1 A_fb1
    v_mov_b32 v13, v12
    s_nop 1
    v_permlane32_swap_b32 v12, v13
    s_nop 1
    v_max_f32 v12, v12, v13
    v_sub_f32 v96, 0, v12
    v_mov_b32 v97, v96
    v_mov_b32 v98, v96
    v_mov_b32 v99, v96
    v_mov_b32 v100, v96
    v_mov_b32 v101, v96
    v_mov_b32 v102, v96
    v_mov_b32 v103, v96
    v_mov_b32 v104, v96
    v_mov_b32 v105, v96
    v_mov_b32 v106, v96
    v_mov_b32 v107, v96
    v_mov_b32 v108, v96
    v_mov_b32 v109, v96
    v_mov_b32 v110, v96
    v_mov_b32 v111, v96
    v_mov_b32 v15, v14
    s_nop 1
    v_permlane32_swap_b32 v14, v15
    s_nop 1
    v_max_f32 v14, v14, v15
    v_sub_f32 v112, 0, v14
    v_mov_b32 v113, v112
    v_mov_b32 v114, v112
    v_mov_b32 v115, v112
    v_mov_b32 v116, v112
    v_mov_b32 v117, v112
    v_mov_b32 v118, v112
    v_mov_b32 v119, v112
    v_mov_b32 v120, v112
    v_mov_b32 v121, v112
    v_mov_b32 v122, v112
    v_mov_b32 v123, v112
    v_mov_b32 v124, v112
    v_mov_b32 v125, v112
    v_mov_b32 v126, v112
    v_mov_b32 v127, v112
    v_accvgpr_write_b32 a32, 0
    v_accvgpr_write_b32 a33, 0
    v_accvgpr_write_b32 a34, 0
    v_accvgpr_write_b32 a35, 0
    v_accvgpr_write_b32 a36, 0
    v_accvgpr_write_b32 a37, 0
    v_accvgpr_write_b32 a38, 0
    v_accvgpr_write_b32 a39, 0
    v_accvgpr_write_b32 a40, 0
    v_accvgpr_write_b32 a41, 0
    v_accvgpr_write_b32 a42, 0
    v_accvgpr_write_b32 a43, 0
    v_accvgpr_write_b32 a44, 0
    v_accvgpr_write_b32 a45, 0
    v_accvgpr_write_b32 a46, 0
    v_accvgpr_write_b32 a47, 0
    v_accvgpr_write_b32 a48, 0
    v_accvgpr_write_b32 a49, 0
    v_accvgpr_write_b32 a50, 0
    v_accvgpr_write_b32 a51, 0
    v_accvgpr_write_b32 a52, 0
    v_accvgpr_write_b32 a53, 0
    v_accvgpr_write_b32 a54, 0
    v_accvgpr_write_b32 a55, 0
    v_accvgpr_write_b32 a56, 0
    v_accvgpr_write_b32 a57, 0
    v_accvgpr_write_b32 a58, 0
    v_accvgpr_write_b32 a59, 0
    v_accvgpr_write_b32 a60, 0
    v_accvgpr_write_b32 a61, 0
    v_accvgpr_write_b32 a62, 0
    v_accvgpr_write_b32 a63, 0
    s_mov_b32 s56, s83
    s_mov_b32 s81, 64
A_fb2:
    buffer_load_dwordx4 a[8:11], v2, s[40:43], s56 offen sc1
    s_mov_b32 exec_lo, 0xffff
    s_mov_b32 exec_hi, 0xffff
    buffer_load_dwordx4 a[24:27], v21, s[40:43], s56 offen offset:1024 sc1
    buffer_load_dwordx4 a[28:31], v21, s[40:43], s56 offen offset:1536 sc1
    s_mov_b64 exec, -1
    s_add_u32 s56, s56, 2048
    s_waitcnt vmcnt(0)
    v_mfma_f32_32x32x16_bf16 v[64:79], a[8:11], a[0:3], v[96:111]
    v_mfma_f32_32x32x16_bf16 v[80:95], a[8:11], a[4:7], v[112:127]
    s_nop 15
    v_exp_f32 v64, v64
    v_exp_f32 v65, v65
    v_exp_f32 v66, v66
    v_exp_f32 v67, v67
    v_exp_f32 v68, v68
    v_exp_f32 v69, v69
    v_exp_f32 v70, v70
    v_exp_f32 v71, v71
    v_exp_f32 v72, v72
    v_exp_f32 v73, v73
    v_exp_f32 v74, v74
    v_exp_f32 v75, v75
    v_exp_f32 v76, v76
    v_exp_f32 v77, v77
    v_exp_f32 v78, v78
    v_exp_f32 v79, v79
    v_exp_f32 v80, v80
    v_exp_f32 v81, v81
    v_exp_f32 v82, v82
    v_exp_f32 v83, v83
    v_exp_f32 v84, v84
    v_exp_f32 v85, v85
    v_exp_f32 v86, v86
    v_exp_f32 v87, v87
    v_exp_f32 v88, v88
    v_exp_f32 v89, v89
    v_exp_f32 v90, v90
    v_exp_f32 v91, v91
    v_exp_f32 v92, v92
    v_exp_f32 v93, v93
    v_exp_f32 v94, v94
    v_exp_f32 v95, v95
    s_nop 1
    v_smfmac_f32_32x32x32_bf16 a[32:47], a[24:27], v[64:71], v28
    v_smfmac_f32_32x32x32_bf16 a[32:47], a[28:31], v[72:79], v28
    v_smfmac_f32_32x32x32_bf16 a[48:63], a[24:27], v[80:87], v28
    v_smfmac_f32_32x32x32_bf16 a[48:63], a[28:31], v[88:95], v28
    s_nop 15
    s_sub_u32 s81, s81, 1
    s_cmp_lg_u32 s81, 0
    s_cbranch_scc1 A_fb2
    s_branch A_fin
L_end:
    s_endpgm
L_codeend:
.section .rodata,"a"
.p2align 6
.amdhsa_kernel gated_mix__softmax_full_mha__dense_activation_gelu__prompt_kernel
  .amdhsa_next_free_vgpr 256
  .amdhsa_next_free_sgpr 102
  .amdhsa_accum_offset 128
  .amdhsa_group_segment_fixed_size 0
  .amdhsa_kernarg_size 96
  .amdhsa_user_sgpr_count 2
  .amdhsa_user_sgpr_kernarg_segment_ptr 1
  .amdhsa_system_sgpr_workgroup_id_x 1
.end_amdhsa_kernel
```
